```python
import torch

def _softmax(x, axis=-1):
    return torch.softmax(x, dim=axis)
def _gelu(x):
    return torch.nn.functional.gelu(x, approximate="tanh")
def _silu(x):
    return torch.nn.functional.silu(x)
def _sigmoid(x):
    return torch.sigmoid(x)
def _layernorm(x, axis=-1, eps=1e-5):
    m = x.mean(dim=axis, keepdim=True)
    v = x.var(dim=axis, keepdim=True, unbiased=False)
    return (x - m) / torch.sqrt(v + eps)
def _scatter_add(tgt, idx, src, axis=0):
    return tgt.clone().index_add_(axis, idx, src)
def _segment_sum(src, seg, n):
    out = torch.zeros((n,) + src.shape[1:], dtype=src.dtype)
    return out.index_add_(0, seg, src)
def _pad(x, pw):
    flat = tuple(v for pair in reversed(pw) for v in pair)
    return torch.nn.functional.pad(x, flat)

kernel_name = 'concat_heads__sliding_block__spectral_fnet__prompt'

def setup_inputs():

    _w = (lambda a: (lambda t: t.to(torch.bfloat16) if t.is_floating_point() else t)(torch.as_tensor(a)))
    def _A_setup():
        B, S, D = 1, 2048, 1024
        return {
            "x": _w((lambda *s: torch.randn(*s, dtype=torch.bfloat16) * 0.2)(B, S, D)),
            "wqkv": _w((lambda *s: torch.randn(*s, dtype=torch.bfloat16) * 0.8)(D, 3 * D)),
            "wo": _w((lambda *s: torch.randn(*s, dtype=torch.bfloat16) * 0.2)(D, D)),
        }
    _A_in = _A_setup()

    def _B_setup():
        B, S, D = 1, 2048, 1024
        ns = torch.arange(S)[:, None] * torch.arange(S)[None, :]
        nd = torch.arange(D)[:, None] * torch.arange(D)[None, :]
        Ws_re = torch.cos(-2.0 * torch.pi * ns / S).to(float)
        Ws_im = torch.sin(-2.0 * torch.pi * ns / S).to(float)
        Wd_re = torch.cos(-2.0 * torch.pi * nd / D).to(float)
        Wd_im = torch.sin(-2.0 * torch.pi * nd / D).to(float)
        return {
            "x": _w((lambda *s: torch.randn(*s, dtype=torch.bfloat16) * 0.05)(B, S, D)),
            "dft_seq_re": _w(Ws_re),
            "dft_seq_im": _w(Ws_im),
            "dft_hid_re": _w(Wd_re),
            "dft_hid_im": _w(Wd_im),
        }
    _B_in = _B_setup()

    return {
        "A_x": _A_in["x"],
        "A_wqkv": _A_in["wqkv"],
        "A_wo": _A_in["wo"],
        "B_x": _B_in["x"],
        "B_dft_seq_re": _B_in["dft_seq_re"],
        "B_dft_seq_im": _B_in["dft_seq_im"],
        "B_dft_hid_re": _B_in["dft_hid_re"],
        "B_dft_hid_im": _B_in["dft_hid_im"],
    }

def reference(A_x, A_wqkv, A_wo, B_x, B_dft_seq_re, B_dft_seq_im, B_dft_hid_re, B_dft_hid_im):
    def _A_ref(x, wqkv, wo):
        B, S, D = x.shape
        H = 32; Dh = D // H; W = 256
        qkv = (lambda x, *d: x.permute(*d))((x @ wqkv).reshape(B, S, 3, H, Dh), 2, 0, 3, 1, 4)
        q, k, v = qkv[0], qkv[1], qkv[2]
        scores = torch.einsum("bhqd,bhkd->bhqk", q, k) * (Dh ** -0.5)
        idx = torch.arange(S)
        mask = (idx[:, None] - idx[None, :] >= 0) & (idx[:, None] - idx[None, :] < W)
        scores = torch.where(mask[None, None], scores, -1e9)
        p = _softmax(scores, axis=-1)
        o = torch.einsum("bhqk,bhkd->bhqd", p, v)
        return (lambda x, *d: x.permute(*d))(o, 0, 2, 1, 3).reshape(B, S, D) @ wo

    def _B_ref(x, dft_seq_re, dft_seq_im, dft_hid_re, dft_hid_im):
        a = torch.einsum("bsd,ed->bse", x, dft_hid_re)
        b = torch.einsum("bsd,ed->bse", x, dft_hid_im)
        y = torch.einsum("ts,bse->bte", dft_seq_re, a) - torch.einsum("ts,bse->bte", dft_seq_im, b)
        return y

    a = _A_ref(A_x, A_wqkv, A_wo)
    b = _B_ref(B_x, B_dft_seq_re, B_dft_seq_im, B_dft_hid_re, B_dft_hid_im)
    return torch.concatenate([a, b], axis=-1)
```

```asm
; @launch grid=(256,1,1) block=(512,1,1) lds=163840
.amdgcn_target "amdgcn-amd-amdhsa--gfx950"
.text
.globl concat_heads__sliding_block__spectral_fnet__prompt_kernel
.p2align 8
.type concat_heads__sliding_block__spectral_fnet__prompt_kernel,@function
concat_heads__sliding_block__spectral_fnet__prompt_kernel:
    s_load_dwordx4 s[4:7], s[0:1], 0
    v_lshrrev_b32 v1, 6, v0
    s_cmp_ge_u32 s2, 256
    s_cbranch_scc1 L_end
    v_readfirstlane_b32 s3, v1
    v_and_b32 v0, 63, v0
    s_and_b32 s80, s2, 7
    s_lshr_b32 s81, s2, 3
    s_and_b32 s82, s81, 15
    s_lshr_b32 s90, s81, 4
    s_lshl_b32 s83, s80, 1
    s_add_u32 s83, s83, s90
    s_cmp_lt_u32 s3, 4
    s_cbranch_scc1 L_compute
    s_sub_u32 s94, s3, 4
    v_lshrrev_b32 v16, 3, v0
    v_lshrrev_b32 v17, 4, v0
    v_and_b32 v18, 7, v0
    v_xor_b32 v19, v18, v17
    v_lshlrev_b32 v19, 4, v19
    v_lshl_add_u32 v2, v16, 11, v19
    s_lshl_b32 s90, s82, 18
    s_lshl_b32 s91, s94, 16
    s_add_u32 s90, s90, s91
    v_add_u32 v2, s90, v2
    v_xor_b32 v3, 64, v2
    v_add_u32 v3, 15360, v3
    v_add_u32 v4, 30720, v2
    v_add_u32 v5, 30720, v3
    v_and_b32 v19, 1, v17
    v_lshlrev_b32 v19, 1, v19
    v_xor_b32 v19, v19, v18
    v_lshlrev_b32 v19, 4, v19
    v_mul_u32_u24 v6, 6144, v16
    v_add_u32 v6, v6, v19
    s_mul_i32 s90, s94, 98304
    s_lshl_b32 s91, s83, 7
    s_add_u32 s90, s90, s91
    v_add_u32 v6, s90, v6
    v_xor_b32 v12, 64, v6
    v_add_u32 v7, 48128, v12
    v_add_u32 v8, 0, v6
    v_add_u32 v9, 51200, v12
    v_add_u32 v10, 3072, v6
    v_add_u32 v11, 51200, v12
    s_lshl_b32 s98, s94, 12
    s_mul_i32 s99, s94, 6144
    s_add_u32 s99, s99, 16384
    s_mul_i32 s96, s80, 640
    s_mul_i32 s90, s82, 512
    s_add_u32 s96, s96, s90
    s_and_b32 s96, s96, 2047
    s_mul_i32 s97, s96, 3072
    s_mov_b32 s95, 81920
    s_waitcnt lgkmcnt(0)
    s_mov_b32 s28, s4
    s_and_b32 s29, s5, 0xffff
    s_mov_b32 s30, 0x400000
    s_mov_b32 s31, 0x20000
    s_mov_b32 s32, s6
    s_and_b32 s33, s7, 0xffff
    s_mov_b32 s34, 0x600000
    s_mov_b32 s35, 0x20000
    s_add_u32 m0, s98, s95
    s_nop 0
    buffer_load_dwordx4 v2, s[28:31], s96 offen offset:0 lds
    buffer_load_dwordx4 v3, s[28:31], s96 offen offset:1024 lds
    buffer_load_dwordx4 v4, s[28:31], s96 offen offset:2048 lds
    buffer_load_dwordx4 v5, s[28:31], s96 offen offset:3072 lds
    s_add_u32 m0, s99, s95
    s_nop 0
    buffer_load_dwordx4 v6, s[32:35], s97 offen offset:0 lds
    buffer_load_dwordx4 v7, s[32:35], s97 offen offset:1024 lds
    buffer_load_dwordx4 v8, s[32:35], s97 offen offset:2048 lds
    s_add_u32 m0, m0, 3072
    s_nop 0
    buffer_load_dwordx4 v9, s[32:35], s97 offen offset:0 lds
    buffer_load_dwordx4 v10, s[32:35], s97 offen offset:1024 lds
    buffer_load_dwordx4 v11, s[32:35], s97 offen offset:2048 lds
    s_add_u32 s96, s96, 128
    s_and_b32 s96, s96, 2047
    s_mul_i32 s97, s96, 3072
    s_add_u32 s95, s95, 40960
    s_cmp_eq_u32 s95, 122880
    s_cselect_b32 s95, 0, s95
    s_add_u32 m0, s98, s95
    s_nop 0
    buffer_load_dwordx4 v2, s[28:31], s96 offen offset:0 lds
    buffer_load_dwordx4 v3, s[28:31], s96 offen offset:1024 lds
    buffer_load_dwordx4 v4, s[28:31], s96 offen offset:2048 lds
    buffer_load_dwordx4 v5, s[28:31], s96 offen offset:3072 lds
    s_add_u32 m0, s99, s95
    s_nop 0
    buffer_load_dwordx4 v6, s[32:35], s97 offen offset:0 lds
    buffer_load_dwordx4 v7, s[32:35], s97 offen offset:1024 lds
    buffer_load_dwordx4 v8, s[32:35], s97 offen offset:2048 lds
    s_add_u32 m0, m0, 3072
    s_nop 0
    buffer_load_dwordx4 v9, s[32:35], s97 offen offset:0 lds
    buffer_load_dwordx4 v10, s[32:35], s97 offen offset:1024 lds
    buffer_load_dwordx4 v11, s[32:35], s97 offen offset:2048 lds
    s_add_u32 s96, s96, 128
    s_and_b32 s96, s96, 2047
    s_mul_i32 s97, s96, 3072
    s_add_u32 s95, s95, 40960
    s_cmp_eq_u32 s95, 122880
    s_cselect_b32 s95, 0, s95
    s_load_dwordx4 s[8:11], s[0:1], 16
    s_load_dwordx4 s[12:15], s[0:1], 48
    s_load_dwordx2 s[16:17], s[0:1], 64
    s_load_dwordx2 s[24:25], s[0:1], 80
    v_lshlrev_b32 v1, 4, v0
    v_mov_b32 v244, 0
    v_mov_b32 v252, 0
    s_lshr_b32 s84, s3, 1
    s_and_b32 s84, s84, 1
    s_and_b32 s90, s3, 1
    s_sub_u32 s91, 3, s90
    s_cmp_lt_u32 s3, 4
    s_cselect_b32 s85, s91, s90
    s_lshl_b32 s86, s83, 1
    s_add_u32 s86, s86, s84
    s_lshl_b32 s87, s82, 2
    s_mov_b32 s88, 0x3e8293ee
    s_and_b32 s90, s80, 3
    s_lshl_b32 s90, s90, 2
    s_and_b32 s91, s81, 3
    s_add_u32 s79, s90, s91
    s_lshr_b32 s90, s80, 2
    s_lshl_b32 s90, s90, 3
    s_lshr_b32 s91, s81, 2
    s_add_u32 s78, s90, s91
    v_mov_b32 v39, 0xff800000
    s_mov_b32 s90, 0xffffffff
    s_mov_b32 s91, 0xfffffff0
    v_cndmask_b32 v40, v39, 0, s[90:91]
    s_mov_b32 s90, 0xfffffffe
    s_mov_b32 s91, 0xffffffe0
    v_cndmask_b32 v41, v39, 0, s[90:91]
    s_mov_b32 s90, 0xfffffffc
    s_mov_b32 s91, 0xffffffc0
    v_cndmask_b32 v42, v39, 0, s[90:91]
    s_mov_b32 s90, 0xfffffff8
    s_mov_b32 s91, 0xffffff80
    v_cndmask_b32 v43, v39, 0, s[90:91]
    s_mov_b32 s90, 0xffff0000
    s_mov_b32 s91, 0xfff00000
    v_cndmask_b32 v44, v39, 0, s[90:91]
    s_mov_b32 s90, 0xfffe0000
    s_mov_b32 s91, 0xffe00000
    v_cndmask_b32 v45, v39, 0, s[90:91]
    s_mov_b32 s90, 0xfffc0000
    s_mov_b32 s91, 0xffc00000
    v_cndmask_b32 v46, v39, 0, s[90:91]
    s_mov_b32 s90, 0xfff80000
    s_mov_b32 s91, 0xff800000
    v_cndmask_b32 v47, v39, 0, s[90:91]
    s_mov_b32 s90, 0xffffff00
    s_mov_b32 s91, 0xfffff000
    v_cndmask_b32 v48, v39, 0, s[90:91]
    s_mov_b32 s90, 0xfffffe00
    s_mov_b32 s91, 0xffffe000
    v_cndmask_b32 v49, v39, 0, s[90:91]
    s_mov_b32 s90, 0xfffffc00
    s_mov_b32 s91, 0xffffc000
    v_cndmask_b32 v50, v39, 0, s[90:91]
    s_mov_b32 s90, 0xfffff800
    s_mov_b32 s91, 0xffff8000
    v_cndmask_b32 v51, v39, 0, s[90:91]
    s_mov_b32 s90, 0xff000000
    s_mov_b32 s91, 0xf0000000
    v_cndmask_b32 v52, v39, 0, s[90:91]
    s_mov_b32 s90, 0xfe000000
    s_mov_b32 s91, 0xe0000000
    v_cndmask_b32 v53, v39, 0, s[90:91]
    s_mov_b32 s90, 0xfc000000
    s_mov_b32 s91, 0xc0000000
    v_cndmask_b32 v54, v39, 0, s[90:91]
    s_mov_b32 s90, 0xf8000000
    s_mov_b32 s91, 0x80000000
    v_cndmask_b32 v55, v39, 0, s[90:91]
    v_mov_b32 v39, 0x3f803f80
    s_mov_b32 s90, 0x10100101
    s_mov_b32 s91, 0x10100101
    v_cndmask_b32 v236, 0, v39, s[90:91]
    v_cndmask_b32 v237, 0, v39, s[90:91]
    v_cndmask_b32 v238, 0, v39, s[90:91]
    v_cndmask_b32 v239, 0, v39, s[90:91]
    s_waitcnt lgkmcnt(0)
    s_mov_b32 s36, s8
    s_and_b32 s37, s9, 0xffff
    s_mov_b32 s38, 0x200000
    s_mov_b32 s39, 0x20000
    s_mov_b32 s40, s10
    s_and_b32 s41, s11, 0xffff
    s_mov_b32 s42, 0x400000
    s_mov_b32 s43, 0x20000
    s_mov_b32 s44, s12
    s_and_b32 s45, s13, 0xffff
    s_mov_b32 s46, 0x200000
    s_mov_b32 s47, 0x20000
    s_mov_b32 s48, s14
    s_and_b32 s49, s15, 0xffff
    s_mov_b32 s50, 0x200000
    s_mov_b32 s51, 0x20000
    s_mov_b32 s52, s16
    s_and_b32 s53, s17, 0xffff
    s_mov_b32 s54, 0x800000
    s_mov_b32 s55, 0x20000
    s_mov_b32 s56, s24
    s_and_b32 s57, s25, 0xffff
    s_mov_b32 s58, 0x1100000
    s_mov_b32 s59, 0x20000
    s_add_u32 s70, s24, 0x10a0000
    s_addc_u32 s71, s25, 0
    s_and_b32 s18, s81, 15
    s_xor_b32 s18, s18, 0
    s_lshl_b32 s18, s18, 1
    s_lshr_b32 s90, s81, 4
    s_add_u32 s18, s18, s90
    s_load_dword s89, s[70:71], 0
    s_getpc_b64 s[22:23]
Lpc_1:
    s_lshl_b32 s90, s81, 2
    s_add_u32 s90, s90, s94
    s_lshl_b32 s90, s90, 8
    s_sub_u32 s22, s22, Lpc_1-concat_heads__sliding_block__spectral_fnet__prompt_kernel
    s_subb_u32 s23, s23, 0
    s_min_u32 s90, s90, L_end-concat_heads__sliding_block__spectral_fnet__prompt_kernel-192
    s_add_u32 s22, s22, s90
    s_addc_u32 s23, s23, 0
    s_load_dword s77, s[22:23], 0
    s_load_dword s77, s[22:23], 64
    s_load_dword s77, s[22:23], 128
    s_load_dword s77, s[22:23], 192
    s_lshl_b32 s90, s2, 2
    s_add_u32 s90, s90, s94
    s_lshl_b32 s90, s90, 11
    s_add_u32 s4, s8, s90
    s_addc_u32 s5, s9, 0
    s_lshl_b32 s90, s81, 2
    s_add_u32 s90, s90, s94
    s_lshl_b32 s90, s90, 4
    s_add_u32 s90, s90, s80
    s_lshl_b32 s90, s90, 11
    s_add_u32 s6, s10, s90
    s_addc_u32 s7, s11, 0
    s_cmp_lt_u32 s94, 2
    s_cselect_b32 s90, 16, 11
    s_lshl_b32 s90, s81, s90
    s_bitcmp1_b32 s94, 0
    s_cselect_b32 s8, s14, s12
    s_cselect_b32 s9, s15, s13
    s_add_u32 s8, s8, s90
    s_addc_u32 s9, s9, 0
    s_mov_b32 s64, 0
    s_mov_b32 s19, 0
    s_and_b32 s91, s3, 1
    s_lshl_b32 s68, s86, 5
    s_add_u32 s68, s68, s91
    s_lshl_b32 s91, s82, 1
    s_add_u32 s68, s68, s91
    s_add_u32 s90, s91, s3
    s_sub_i32 s69, s90, 8
    s_max_i32 s90, s69, 0
    s_lshl_b32 s91, s83, 6
    s_add_u32 s90, s90, s91
    s_lshl_b32 s91, s90, 7
    s_add_u32 s91, s91, 0x1000000
    v_lshl_add_u32 v252, v0, 12, s91
    s_lshl_b32 s72, s90, 13
    s_lshl_b32 s73, s94, 12
    v_and_b32 v20, 12, v0
    v_lshlrev_b32 v20, 16, v20
    v_lshrrev_b32 v21, 4, v0
    v_lshl_add_u32 v20, v21, 16, v20
    v_and_b32 v21, 1, v21
    v_and_b32 v22, 3, v0
    v_xor_b32 v21, v21, v22
    v_lshl_add_u32 v20, v21, 4, v20
    s_lshl_b32 s90, s94, 14
    s_lshl_b32 s91, s80, 11
    s_add_u32 s90, s90, s91
    s_lshl_b32 s91, s18, 6
    s_add_u32 s90, s90, s91
    v_add_u32 v224, s90, v20
    v_lshrrev_b32 v21, 2, v0
    v_and_b32 v22, 48, v1
    s_cmp_lt_u32 s94, 2
    s_cselect_b32 s91, 16, 11
    v_lshlrev_b32 v21, s91, v21
    v_add_u32 v225, v21, v22
    v_lshlrev_b32 v13, 11, v0
    s_mov_b32 s93, 0
L_lloop:
    s_waitcnt vmcnt(10)
    s_barrier
    s_add_u32 m0, s98, s95
    s_nop 0
    buffer_load_dwordx4 v2, s[28:31], s96 offen offset:0 lds
    buffer_load_dwordx4 v3, s[28:31], s96 offen offset:1024 lds
    buffer_load_dwordx4 v4, s[28:31], s96 offen offset:2048 lds
    buffer_load_dwordx4 v5, s[28:31], s96 offen offset:3072 lds
    s_add_u32 m0, s99, s95
    s_nop 0
    buffer_load_dwordx4 v6, s[32:35], s97 offen offset:0 lds
    buffer_load_dwordx4 v7, s[32:35], s97 offen offset:1024 lds
    buffer_load_dwordx4 v8, s[32:35], s97 offen offset:2048 lds
    s_add_u32 m0, m0, 3072
    s_nop 0
    buffer_load_dwordx4 v9, s[32:35], s97 offen offset:0 lds
    buffer_load_dwordx4 v10, s[32:35], s97 offen offset:1024 lds
    buffer_load_dwordx4 v11, s[32:35], s97 offen offset:2048 lds
    s_add_u32 s96, s96, 128
    s_and_b32 s96, s96, 2047
    s_mul_i32 s97, s96, 3072
    s_add_u32 s95, s95, 40960
    s_cmp_eq_u32 s95, 122880
    s_cselect_b32 s95, 0, s95
    s_cmp_eq_u32 s93, 9
    s_cbranch_scc0 Lxb_2
    s_bitcmp1_b32 s83, 0
    s_cbranch_scc1 Lxb_2
    s_lshl_b32 s91, s94, 12
    s_add_u32 m0, s91, 139264
    s_mov_b32 s90, 0
    buffer_load_dwordx4 v224, s[40:43], s90 offen offset:0 lds
    s_add_u32 s90, s90, 0xffc00
    buffer_load_dwordx4 v224, s[40:43], s90 offen offset:1024 lds
    s_add_u32 s90, s90, 0xffc00
    buffer_load_dwordx4 v224, s[40:43], s90 offen offset:2048 lds
    s_add_u32 s90, s90, 0xffc00
    buffer_load_dwordx4 v224, s[40:43], s90 offen offset:3072 lds
    s_cmp_lt_u32 s94, 2
    s_cselect_b32 s91, 16, 11
    s_lshl_b32 s92, 16, s91
    s_sub_u32 s92, s92, 1024
    s_lshl_b32 s91, s94, 11
    s_add_u32 m0, s91, 155648
    s_bitcmp1_b32 s3, 0
    s_cbranch_scc1 Lct_3
    buffer_load_dwordx4 v225, s[44:47], 0 offen lds
    buffer_load_dwordx4 v225, s[44:47], s92 offen offset:1024 lds
    s_branch Lct_4
Lct_3:
    buffer_load_dwordx4 v225, s[48:51], 0 offen lds
    buffer_load_dwordx4 v225, s[48:51], s92 offen offset:1024 lds
Lct_4:
    s_cmp_ge_u32 s93, 3
    s_cbranch_scc0 Lsp_5
    s_cmp_lt_u32 s19, 8
    s_cbranch_scc0 Lsp_5
    s_load_dwordx2 s[10:11], s[4:5], 60
    s_load_dwordx2 s[12:13], s[4:5], 188
    s_add_u32 s4, s4, 256
    s_addc_u32 s5, s5, 0
    s_add_u32 s19, s19, 1
    s_and_b32 s90, s19, 7
    s_cbranch_scc1 Lsp_5
    s_mov_b64 s[4:5], s[6:7]
    s_add_u32 s6, s6, 0x4000
    s_addc_u32 s7, s7, 0
    s_load_dword s10, s[8:9], 0
Lsp_5:
    s_waitcnt vmcnt(16)
    s_barrier
    s_add_u32 m0, s98, s95
    s_nop 0
    buffer_load_dwordx4 v2, s[28:31], s96 offen offset:0 lds
    buffer_load_dwordx4 v3, s[28:31], s96 offen offset:1024 lds
    buffer_load_dwordx4 v4, s[28:31], s96 offen offset:2048 lds
    buffer_load_dwordx4 v5, s[28:31], s96 offen offset:3072 lds
    s_add_u32 m0, s99, s95
    s_nop 0
    buffer_load_dwordx4 v6, s[32:35], s97 offen offset:0 lds
    buffer_load_dwordx4 v7, s[32:35], s97 offen offset:1024 lds
    buffer_load_dwordx4 v8, s[32:35], s97 offen offset:2048 lds
    s_add_u32 m0, m0, 3072
    s_nop 0
    buffer_load_dwordx4 v9, s[32:35], s97 offen offset:0 lds
    buffer_load_dwordx4 v10, s[32:35], s97 offen offset:1024 lds
    buffer_load_dwordx4 v11, s[32:35], s97 offen offset:2048 lds
    s_add_u32 s96, s96, 128
    s_and_b32 s96, s96, 2047
    s_mul_i32 s97, s96, 3072
    s_add_u32 s95, s95, 40960
    s_cmp_eq_u32 s95, 122880
    s_cselect_b32 s95, 0, s95
    s_cmp_ge_u32 s93, 3
    s_cbranch_scc0 Lsp_6
    s_cmp_lt_u32 s19, 8
    s_cbranch_scc0 Lsp_6
    s_load_dwordx2 s[10:11], s[4:5], 60
    s_load_dwordx2 s[12:13], s[4:5], 188
    s_add_u32 s4, s4, 256
    s_addc_u32 s5, s5, 0
    s_add_u32 s19, s19, 1
    s_and_b32 s90, s19, 7
    s_cbranch_scc1 Lsp_6
    s_mov_b64 s[4:5], s[6:7]
    s_add_u32 s6, s6, 0x4000
    s_addc_u32 s7, s7, 0
    s_load_dword s10, s[8:9], 0
Lsp_6:
    s_waitcnt vmcnt(16)
    s_barrier
    s_add_u32 m0, s98, s95
    s_nop 0
    buffer_load_dwordx4 v2, s[28:31], s96 offen offset:0 lds
    buffer_load_dwordx4 v3, s[28:31], s96 offen offset:1024 lds
    buffer_load_dwordx4 v4, s[28:31], s96 offen offset:2048 lds
    buffer_load_dwordx4 v5, s[28:31], s96 offen offset:3072 lds
    s_add_u32 m0, s99, s95
    s_nop 0
    buffer_load_dwordx4 v6, s[32:35], s97 offen offset:0 lds
    buffer_load_dwordx4 v7, s[32:35], s97 offen offset:1024 lds
    buffer_load_dwordx4 v8, s[32:35], s97 offen offset:2048 lds
    s_add_u32 m0, m0, 3072
    s_nop 0
    buffer_load_dwordx4 v9, s[32:35], s97 offen offset:0 lds
    buffer_load_dwordx4 v10, s[32:35], s97 offen offset:1024 lds
    buffer_load_dwordx4 v11, s[32:35], s97 offen offset:2048 lds
    s_add_u32 s96, s96, 128
    s_and_b32 s96, s96, 2047
    s_mul_i32 s97, s96, 3072
    s_add_u32 s95, s95, 40960
    s_cmp_eq_u32 s95, 122880
    s_cselect_b32 s95, 0, s95
    s_add_u32 s93, s93, 2
Lxb_2:
    s_cmp_eq_u32 s93, 3
    s_cbranch_scc0 Lid_7
    s_waitcnt lgkmcnt(0)
    s_mul_i32 s89, s89, 0x9e3779b1
    s_add_u32 s89, s89, 0x7f4a7c15
    s_getreg_b32 s64, hwreg(HW_REG_XCC_ID, 0, 4)
    s_add_u32 s64, s64, s89
    s_cmp_eq_u32 s3, 4
    s_cbranch_scc0 Lid_7
    s_lshl_b32 s90, s83, 4
    s_add_u32 s90, s90, s82
    s_lshl_b32 s90, s90, 7
    s_add_u32 s90, s90, 0x10b0000
    v_lshl_add_u32 v250, v0, 2, s90
    v_mov_b32 v251, s64
    s_mov_b32 exec_hi, 0
    buffer_store_dword v251, v250, s[56:59], 0 offen sc1
    s_mov_b32 exec_hi, -1
Lid_7:
    s_cmp_ge_u32 s93, 3
    s_cbranch_scc0 Lsp_8
    s_cmp_lt_u32 s19, 8
    s_cbranch_scc0 Lsp_8
    s_load_dwordx2 s[10:11], s[4:5], 60
    s_load_dwordx2 s[12:13], s[4:5], 188
    s_add_u32 s4, s4, 256
    s_addc_u32 s5, s5, 0
    s_add_u32 s19, s19, 1
    s_and_b32 s90, s19, 7
    s_cbranch_scc1 Lsp_8
    s_mov_b64 s[4:5], s[6:7]
    s_add_u32 s6, s6, 0x4000
    s_addc_u32 s7, s7, 0
    s_load_dword s10, s[8:9], 0
Lsp_8:
    s_cmp_eq_u32 s93, 11
    s_cbranch_scc0 Lct_9
    s_getpc_b64 s[22:23]
Lpc_10:
    s_lshl_b32 s90, s81, 2
    s_add_u32 s90, s90, s94
    s_lshl_b32 s90, s90, 8
    s_sub_u32 s22, s22, Lpc_10-concat_heads__sliding_block__spectral_fnet__prompt_kernel
    s_subb_u32 s23, s23, 0
    s_min_u32 s90, s90, L_end-concat_heads__sliding_block__spectral_fnet__prompt_kernel-192
    s_add_u32 s22, s22, s90
    s_addc_u32 s23, s23, 0
    s_load_dword s77, s[22:23], 0
    s_load_dword s77, s[22:23], 64
    s_load_dword s77, s[22:23], 128
    s_load_dword s77, s[22:23], 192
    s_add_u32 s90, s82, 1
    s_min_u32 s90, s90, 15
    s_lshl_b32 s91, s83, 4
    s_add_u32 s90, s90, s91
    s_lshl_b32 s90, s90, 7
    s_add_u32 s90, s90, 0x10b0000
    s_load_dword s20, s[24:25], s90
    s_add_u32 s90, s82, 2
    s_min_u32 s90, s90, 15
    s_lshl_b32 s91, s83, 4
    s_add_u32 s90, s90, s91
    s_lshl_b32 s90, s90, 7
    s_add_u32 s90, s90, 0x10b0000
    s_load_dword s21, s[24:25], s90
    s_lshl_b32 s90, s68, 7
    s_add_u32 s90, s90, 0x100003c
    s_load_dwordx2 s[14:15], s[24:25], s90
Lct_9:
    s_add_u32 s93, s93, 1
    s_cmp_lt_u32 s93, 14
    s_cbranch_scc1 L_lloop
    s_and_b32 s90, s81, 3
    s_lshl_b32 s90, s90, 2
    s_add_u32 s90, s90, s94
    s_mul_i32 s90, s90, 131072
    s_lshl_b32 s91, s78, 7
    s_add_u32 s90, s90, s91
    buffer_load_dword v249, v13, s[36:39], s90 offen
    s_bitcmp1_b32 s83, 0
    s_cbranch_scc1 Lt_11
    s_waitcnt vmcnt(11)
    s_barrier
    s_waitcnt vmcnt(1)
    s_barrier
    s_branch Lt_12
Lt_11:
    s_lshl_b32 s91, s94, 12
    s_add_u32 m0, s91, 139264
    s_mov_b32 s90, 0
    buffer_load_dwordx4 v224, s[40:43], s90 offen offset:0 lds
    s_add_u32 s90, s90, 0xffc00
    buffer_load_dwordx4 v224, s[40:43], s90 offen offset:1024 lds
    s_add_u32 s90, s90, 0xffc00
    buffer_load_dwordx4 v224, s[40:43], s90 offen offset:2048 lds
    s_add_u32 s90, s90, 0xffc00
    buffer_load_dwordx4 v224, s[40:43], s90 offen offset:3072 lds
    s_cmp_lt_u32 s94, 2
    s_cselect_b32 s91, 16, 11
    s_lshl_b32 s92, 16, s91
    s_sub_u32 s92, s92, 1024
    s_lshl_b32 s91, s94, 11
    s_add_u32 m0, s91, 155648
    s_bitcmp1_b32 s3, 0
    s_cbranch_scc1 Lct_13
    buffer_load_dwordx4 v225, s[44:47], 0 offen lds
    buffer_load_dwordx4 v225, s[44:47], s92 offen offset:1024 lds
    s_branch Lct_14
Lct_13:
    buffer_load_dwordx4 v225, s[48:51], 0 offen lds
    buffer_load_dwordx4 v225, s[48:51], s92 offen offset:1024 lds
Lct_14:
    s_waitcnt vmcnt(17)
    s_barrier
    s_waitcnt vmcnt(7)
    s_barrier
Lt_12:
    v_lshrrev_b32 v120, 1, v0
    v_and_b32 v120, 1, v120
    s_lshl_b32 s90, s94, 1
    v_add_u32 v120, s90, v120
    v_and_b32 v121, 1, v0
    v_lshl_add_u32 v122, v120, 1, v121
    v_cmp_eq_u32 vcc, 1, v122
    v_cvt_f32_u32 v120, v120
    v_cvt_f32_u32 v121, v121
    v_mul_f32 v120, 0x3d800000, v120
    v_mul_f32 v121, 0x3e800000, v121
    v_cndmask_b32 v120, v120, 0.5, vcc
    v_cndmask_b32 v121, v121, 0, vcc
    v_cos_f32 v124, v121
    v_add_f32 v121, v121, v120
    v_cos_f32 v125, v121
    v_add_f32 v121, v121, v120
    v_cos_f32 v126, v121
    v_add_f32 v121, v121, v120
    v_cos_f32 v127, v121
    v_add_f32 v121, v121, v120
    v_cos_f32 v128, v121
    v_add_f32 v121, v121, v120
    v_cos_f32 v129, v121
    v_add_f32 v121, v121, v120
    v_cos_f32 v130, v121
    v_add_f32 v121, v121, v120
    v_cos_f32 v131, v121
    v_add_f32 v121, v121, v120
    v_cos_f32 v132, v121
    v_add_f32 v121, v121, v120
    v_cos_f32 v133, v121
    v_add_f32 v121, v121, v120
    v_cos_f32 v134, v121
    v_add_f32 v121, v121, v120
    v_cos_f32 v135, v121
    v_add_f32 v121, v121, v120
    v_cos_f32 v136, v121
    v_add_f32 v121, v121, v120
    v_cos_f32 v137, v121
    v_add_f32 v121, v121, v120
    v_cos_f32 v138, v121
    v_add_f32 v121, v121, v120
    v_cos_f32 v139, v121
    s_mov_b32 vcc_lo, 0xf0000f
    s_mov_b32 vcc_hi, 0xf0000f00
    v_cvt_pk_bf16_f32 v124, v124, v125
    v_cndmask_b32 v200, 0, v124, vcc
    v_cvt_pk_bf16_f32 v125, v126, v127
    v_cndmask_b32 v201, 0, v125, vcc
    v_cvt_pk_bf16_f32 v126, v128, v129
    v_cndmask_b32 v202, 0, v126, vcc
    v_cvt_pk_bf16_f32 v127, v130, v131
    v_cndmask_b32 v203, 0, v127, vcc
    v_cvt_pk_bf16_f32 v128, v132, v133
    v_cndmask_b32 v204, 0, v128, vcc
    v_cvt_pk_bf16_f32 v129, v134, v135
    v_cndmask_b32 v205, 0, v129, vcc
    v_cvt_pk_bf16_f32 v130, v136, v137
    v_cndmask_b32 v206, 0, v130, vcc
    v_cvt_pk_bf16_f32 v131, v138, v139
    v_cndmask_b32 v207, 0, v131, vcc
    v_and_b32 v120, 15, v0
    v_lshlrev_b32 v120, 4, v120
    v_add_u32 v121, s90, v120
    v_add_u32 v122, 1, v121
    v_add_u32 v123, 8, v120
    v_subrev_u32 v120, 128, v120
    s_mov_b32 vcc_lo, 0x00ff00ff
    s_mov_b32 vcc_hi, 0x00ff00ff
    v_cndmask_b32 v123, v120, v123, vcc
    s_cmp_eq_u32 s94, 0
    s_cselect_b64 vcc, -1, 0
    v_cndmask_b32 v121, v121, v123, vcc
    v_lshrrev_b32 v120, 2, v0
    v_and_b32 v120, 12, v120
    v_cvt_f32_u32 v120, v120
    v_cvt_f32_u32 v123, v121
    v_mul_f32 v123, 0x3b800000, v123
    v_mul_f32 v140, v120, v123
    v_cos_f32 v124, v140
    v_sin_f32 v128, v140
    v_add_f32 v140, v140, v123
    v_cos_f32 v125, v140
    v_sin_f32 v129, v140
    v_add_f32 v140, v140, v123
    v_cos_f32 v126, v140
    v_sin_f32 v130, v140
    v_add_f32 v140, v140, v123
    v_cos_f32 v127, v140
    v_sin_f32 v131, v140
    v_cvt_pk_bf16_f32 v208, v124, v125
    v_cvt_pk_bf16_f32 v210, v128, v129
    v_xor_b32 v212, 0x80008000, v210
    v_mov_b32 v214, v208
    v_cvt_pk_bf16_f32 v209, v126, v127
    v_cvt_pk_bf16_f32 v211, v130, v131
    v_xor_b32 v213, 0x80008000, v211
    v_mov_b32 v215, v209
    v_cvt_f32_u32 v123, v122
    v_mul_f32 v123, 0x3b800000, v123
    v_mul_f32 v140, v120, v123
    v_cos_f32 v124, v140
    v_sin_f32 v128, v140
    v_add_f32 v140, v140, v123
    v_cos_f32 v125, v140
    v_sin_f32 v129, v140
    v_add_f32 v140, v140, v123
    v_cos_f32 v126, v140
    v_sin_f32 v130, v140
    v_add_f32 v140, v140, v123
    v_cos_f32 v127, v140
    v_sin_f32 v131, v140
    v_cvt_pk_bf16_f32 v216, v124, v125
    v_cvt_pk_bf16_f32 v218, v128, v129
    v_xor_b32 v220, 0x80008000, v218
    v_mov_b32 v222, v216
    v_cvt_pk_bf16_f32 v217, v126, v127
    v_cvt_pk_bf16_f32 v219, v130, v131
    v_xor_b32 v221, 0x80008000, v219
    v_mov_b32 v223, v217
    s_cmp_eq_u32 s3, 4
    s_cbranch_scc0 Lb1c_15
    s_mov_b32 s90, 0x01000100
    s_mov_b32 s91, 0x01000100
    s_mov_b32 vcc_lo, 0x00ff00ff
    s_mov_b32 vcc_hi, 0x00ff00ff
    v_mov_b32 v120, 0xbf803f80
    v_cndmask_b32 v212, v212, v120, s[90:91]
    v_cndmask_b32 v210, 0, v208, vcc
    v_cndmask_b32 v214, 0, v212, vcc
    v_cndmask_b32 v208, v208, 0, vcc
    v_cndmask_b32 v212, v212, 0, vcc
    v_cndmask_b32 v213, v213, v120, s[90:91]
    v_cndmask_b32 v211, 0, v209, vcc
    v_cndmask_b32 v215, 0, v213, vcc
    v_cndmask_b32 v209, v209, 0, vcc
    v_cndmask_b32 v213, v213, 0, vcc
Lb1c_15:
    v_and_b32 v120, 60, v0
    v_lshlrev_b32 v121, 4, v120
    v_and_b32 v122, 1, v0
    v_lshl_add_u32 v121, v122, 5, v121
    v_and_b32 v122, 2, v0
    v_lshl_add_u32 v121, v122, 2, v121
    v_and_b32 v122, 16, v0
    v_add_u32 v121, v121, v122
    v_add_u32 v240, 139264, v121
    v_xor_b32 v241, 16, v240
    v_lshrrev_b32 v121, 1, v0
    v_lshrrev_b32 v122, 4, v0
    v_xor_b32 v121, v121, v122
    v_and_b32 v121, 3, v121
    v_lshlrev_b32 v121, 4, v121
    v_and_b32 v122, 15, v0
    v_lshl_add_u32 v121, v122, 6, v121
    s_lshl_b32 s90, s94, 12
    v_add_u32 v242, s90, v121
    v_add_u32 v243, s90, v1
    v_lshrrev_b32 v121, 3, v0
    v_xor_b32 v121, v121, v0
    v_and_b32 v121, 3, v121
    v_lshlrev_b32 v121, 4, v121
    v_lshl_add_u32 v244, v120, 13, v121
    s_lshl_b32 s90, s94, 20
    s_lshl_b32 s91, s80, 12
    s_add_u32 s90, s90, s91
    s_lshl_b32 s91, s18, 6
    s_add_u32 s90, s90, s91
    s_add_u32 s66, s90, 0xc00000
    s_add_u32 s67, s66, 0x80000
    v_add_u32 v242, 65536, v242
    v_add_u32 v243, 65536, v243
    s_waitcnt vmcnt(0)
    s_and_b32 s90, s3, 3
    s_lshl_b32 s90, s90, 13
    v_add_u32 v4, s90, v1
    s_lshl_b32 s90, s84, 2
    s_add_u32 s90, s90, s85
    s_lshl_b32 s91, s90, 11
    s_add_u32 s91, s91, 122880
    v_add_u32 v2, s91, v1
    s_lshl_b32 s91, s90, 12
    v_add_u32 v3, s91, v1
    s_lshl_b32 s91, s84, 14
    v_add_u32 v6, s91, v1
    s_lshl_b32 s90, s68, 13
    s_add_u32 s91, s90, 4096
    s_lshl_b32 s92, s68, 7
    s_add_u32 s92, s92, 0x1000000
    s_waitcnt lgkmcnt(0)
    s_cmp_eq_u32 s20, s64
    s_cselect_b32 s65, 1, 0
    s_cmp_eq_u32 s21, s64
    s_cselect_b32 s65, s65, 0
    s_barrier
    ds_read_b128 v[120:123], v4 offset:0
    ds_read_b128 v[124:127], v4 offset:1024
    ds_read_b128 v[128:131], v4 offset:2048
    ds_read_b128 v[132:135], v4 offset:3072
    ds_read_b128 v[136:139], v4 offset:4096
    ds_read_b128 v[140:143], v4 offset:5120
    ds_read_b128 v[144:147], v4 offset:6144
    ds_read_b128 v[148:151], v4 offset:7168
    s_waitcnt lgkmcnt(7)
    buffer_store_dwordx4 v[120:123], v1, s[56:59], s90 offen offset:0 sc1
    s_waitcnt lgkmcnt(6)
    buffer_store_dwordx4 v[124:127], v1, s[56:59], s90 offen offset:1024 sc1
    s_waitcnt lgkmcnt(5)
    buffer_store_dwordx4 v[128:131], v1, s[56:59], s90 offen offset:2048 sc1
    s_waitcnt lgkmcnt(4)
    buffer_store_dwordx4 v[132:135], v1, s[56:59], s90 offen offset:3072 sc1
    s_waitcnt lgkmcnt(3)
    buffer_store_dwordx4 v[136:139], v1, s[56:59], s91 offen offset:0 sc1
    s_waitcnt lgkmcnt(2)
    buffer_store_dwordx4 v[140:143], v1, s[56:59], s91 offen offset:1024 sc1
    s_waitcnt lgkmcnt(1)
    buffer_store_dwordx4 v[144:147], v1, s[56:59], s91 offen offset:2048 sc1
    s_waitcnt lgkmcnt(0)
    buffer_store_dwordx4 v[148:151], v1, s[56:59], s91 offen offset:3072 sc1
    ds_read_b128 v[56:59], v3 offset:0
    ds_read_b128 v[60:63], v3 offset:1024
    ds_read_b128 v[72:75], v6 offset:0
    ds_read_b128 v[76:79], v6 offset:1024
    ds_read_b128 v[64:67], v3 offset:2048
    ds_read_b128 v[68:71], v3 offset:3072
    ds_read_b128 v[80:83], v6 offset:2048
    ds_read_b128 v[84:87], v6 offset:3072
    s_waitcnt lgkmcnt(0)
    s_barrier
    s_setprio 1
    ds_read_b64_tr_b16 v[88:89], v240 offset:0
    ds_read_b64_tr_b16 v[90:91], v240 offset:1024
    ds_read_b64_tr_b16 v[92:93], v241 offset:0
    ds_read_b64_tr_b16 v[94:95], v241 offset:1024
    ds_read_b64_tr_b16 v[96:97], v240 offset:2048
    ds_read_b64_tr_b16 v[98:99], v240 offset:3072
    ds_read_b64_tr_b16 v[100:101], v241 offset:2048
    ds_read_b64_tr_b16 v[102:103], v241 offset:3072
    ds_read_b64_tr_b16 v[104:105], v240 offset:4096
    ds_read_b64_tr_b16 v[106:107], v240 offset:5120
    ds_read_b64_tr_b16 v[108:109], v241 offset:4096
    ds_read_b64_tr_b16 v[110:111], v241 offset:5120
    ds_read_b64_tr_b16 v[112:113], v240 offset:6144
    ds_read_b64_tr_b16 v[114:115], v240 offset:7168
    ds_read_b64_tr_b16 v[116:117], v241 offset:6144
    ds_read_b64_tr_b16 v[118:119], v241 offset:7168
    s_waitcnt lgkmcnt(8)
    v_mfma_f32_16x16x32_bf16 v[152:155], v[200:203], v[88:91], 0
    ds_read_b64_tr_b16 v[120:121], v240 offset:8192
    ds_read_b64_tr_b16 v[122:123], v240 offset:9216
    v_mfma_f32_16x16x32_bf16 v[168:171], v[200:203], v[92:95], 0
    ds_read_b64_tr_b16 v[124:125], v241 offset:8192
    ds_read_b64_tr_b16 v[126:127], v241 offset:9216
    v_mfma_f32_16x16x32_bf16 v[152:155], v[204:207], v[96:99], v[152:155]
    ds_read_b64_tr_b16 v[128:129], v240 offset:10240
    ds_read_b64_tr_b16 v[130:131], v240 offset:11264
    v_mfma_f32_16x16x32_bf16 v[168:171], v[204:207], v[100:103], v[168:171]
    ds_read_b64_tr_b16 v[132:133], v241 offset:10240
    ds_read_b64_tr_b16 v[134:135], v241 offset:11264
    s_waitcnt lgkmcnt(8)
    v_mfma_f32_16x16x32_bf16 v[156:159], v[200:203], v[104:107], 0
    ds_read_b64_tr_b16 v[136:137], v240 offset:12288
    ds_read_b64_tr_b16 v[138:139], v240 offset:13312
    v_mfma_f32_16x16x32_bf16 v[172:175], v[200:203], v[108:111], 0
    ds_read_b64_tr_b16 v[140:141], v241 offset:12288
    ds_read_b64_tr_b16 v[142:143], v241 offset:13312
    v_mfma_f32_16x16x32_bf16 v[156:159], v[204:207], v[112:115], v[156:159]
    ds_read_b64_tr_b16 v[144:145], v240 offset:14336
    ds_read_b64_tr_b16 v[146:147], v240 offset:15360
    v_mfma_f32_16x16x32_bf16 v[172:175], v[204:207], v[116:119], v[172:175]
    ds_read_b64_tr_b16 v[148:149], v241 offset:14336
    ds_read_b64_tr_b16 v[150:151], v241 offset:15360
    s_waitcnt lgkmcnt(8)
    v_mfma_f32_16x16x32_bf16 v[160:163], v[200:203], v[120:123], 0
    v_mfma_f32_16x16x32_bf16 v[176:179], v[200:203], v[124:127], 0
    v_mfma_f32_16x16x32_bf16 v[160:163], v[204:207], v[128:131], v[160:163]
    v_mfma_f32_16x16x32_bf16 v[176:179], v[204:207], v[132:135], v[176:179]
    s_waitcnt lgkmcnt(0)
    v_mfma_f32_16x16x32_bf16 v[164:167], v[200:203], v[136:139], 0
    v_mfma_f32_16x16x32_bf16 v[180:183], v[200:203], v[140:143], 0
    v_mfma_f32_16x16x32_bf16 v[164:167], v[204:207], v[144:147], v[164:167]
    v_mfma_f32_16x16x32_bf16 v[180:183], v[204:207], v[148:151], v[180:183]
    v_cvt_pk_bf16_f32 v88, v152, v156
    v_cvt_pk_bf16_f32 v90, v153, v157
    v_cvt_pk_bf16_f32 v92, v154, v158
    v_cvt_pk_bf16_f32 v94, v155, v159
    v_cvt_pk_bf16_f32 v96, v168, v172
    v_cvt_pk_bf16_f32 v98, v169, v173
    v_cvt_pk_bf16_f32 v100, v170, v174
    v_cvt_pk_bf16_f32 v102, v171, v175
    v_cvt_pk_bf16_f32 v89, v160, v164
    v_cvt_pk_bf16_f32 v91, v161, v165
    v_cvt_pk_bf16_f32 v93, v162, v166
    v_cvt_pk_bf16_f32 v95, v163, v167
    v_cvt_pk_bf16_f32 v97, v176, v180
    v_cvt_pk_bf16_f32 v99, v177, v181
    v_cvt_pk_bf16_f32 v101, v178, v182
    v_cvt_pk_bf16_f32 v103, v179, v183
    v_mfma_f32_16x16x32_bf16 v[104:107], v[88:91], v[208:211], 0
    v_mfma_f32_16x16x32_bf16 v[108:111], v[96:99], v[208:211], 0
    v_mfma_f32_16x16x32_bf16 v[112:115], v[88:91], v[212:215], 0
    v_mfma_f32_16x16x32_bf16 v[116:119], v[96:99], v[212:215], 0
    v_mfma_f32_16x16x32_bf16 v[120:123], v[92:95], v[216:219], 0
    v_mfma_f32_16x16x32_bf16 v[124:127], v[100:103], v[216:219], 0
    v_mfma_f32_16x16x32_bf16 v[128:131], v[92:95], v[220:223], 0
    v_mfma_f32_16x16x32_bf16 v[132:135], v[100:103], v[220:223], 0
    s_nop 0
    v_cvt_pk_bf16_f32 v136, v104, v105
    v_cvt_pk_bf16_f32 v137, v106, v107
    v_cvt_pk_bf16_f32 v138, v108, v109
    v_cvt_pk_bf16_f32 v139, v110, v111
    ds_write_b128 v242, v[136:139] offset:0
    v_cvt_pk_bf16_f32 v140, v112, v113
    v_cvt_pk_bf16_f32 v141, v114, v115
    v_cvt_pk_bf16_f32 v142, v116, v117
    v_cvt_pk_bf16_f32 v143, v118, v119
    ds_write_b128 v242, v[140:143] offset:1024
    v_cvt_pk_bf16_f32 v144, v120, v121
    v_cvt_pk_bf16_f32 v145, v122, v123
    v_cvt_pk_bf16_f32 v146, v124, v125
    v_cvt_pk_bf16_f32 v147, v126, v127
    ds_write_b128 v242, v[144:147] offset:2048
    v_cvt_pk_bf16_f32 v148, v128, v129
    v_cvt_pk_bf16_f32 v149, v130, v131
    v_cvt_pk_bf16_f32 v150, v132, v133
    v_cvt_pk_bf16_f32 v151, v134, v135
    ds_write_b128 v242, v[148:151] offset:3072
    ds_read_b128 v[200:203], v243 offset:0
    ds_read_b128 v[204:207], v243 offset:1024
    ds_read_b128 v[208:211], v243 offset:2048
    ds_read_b128 v[212:215], v243 offset:3072
    s_waitcnt vmcnt(0)
    s_cmp_eq_u32 s65, 1
    s_cbranch_scc0 Lw_16
    v_lshl_add_u32 v250, v0, 2, s92
    v_mov_b32 v251, s89
    s_mov_b32 exec_hi, 0
    buffer_store_dword v251, v250, s[56:59], 0 offen
    s_mov_b32 exec_hi, -1
    s_branch Lw_17
Lw_16:
    v_lshl_add_u32 v250, v0, 2, s92
    v_mov_b32 v251, s89
    s_mov_b32 exec_hi, 0
    buffer_store_dword v251, v250, s[56:59], 0 offen sc1
    s_mov_b32 exec_hi, -1
Lw_17:
    s_cmp_lt_i32 s69, 0
    s_cbranch_scc1 Lhf_18
    s_mov_b32 s96, 0
    s_mov_b64 exec, 0x3
Lp_19:
    buffer_load_dword v253, v252, s[56:59], 0 offen sc1
Lpe_21:
    s_add_u32 s96, s96, 1
    s_waitcnt vmcnt(0)
    v_cmp_ne_u32 vcc, s89, v253
    s_cmp_ge_u32 s96, 32768
    s_cbranch_scc1 Lpd_20
    s_cbranch_vccz Lpd_20
    s_branch Lp_19
Lpd_20:
    s_mov_b64 exec, -1
    s_add_u32 m0, s73, 32768
    s_add_u32 s91, s72, 0
    buffer_load_dwordx4 v1, s[56:59], s91 offen offset:0 sc1 lds
    buffer_load_dwordx4 v1, s[56:59], s91 offen offset:1024 sc1 lds
    s_add_u32 m0, s73, 34816
    s_add_u32 s91, s72, 4096
    buffer_load_dwordx4 v1, s[56:59], s91 offen offset:0 sc1 lds
    buffer_load_dwordx4 v1, s[56:59], s91 offen offset:1024 sc1 lds
    s_add_u32 m0, s73, 49152
    s_add_u32 s91, s72, 262144
    buffer_load_dwordx4 v1, s[56:59], s91 offen offset:0 sc1 lds
    buffer_load_dwordx4 v1, s[56:59], s91 offen offset:1024 sc1 lds
    s_add_u32 m0, s73, 51200
    s_add_u32 s91, s72, 266240
    buffer_load_dwordx4 v1, s[56:59], s91 offen offset:0 sc1 lds
    buffer_load_dwordx4 v1, s[56:59], s91 offen offset:1024 sc1 lds
    s_add_u32 m0, s73, 0
    s_add_u32 s91, s72, 2048
    buffer_load_dwordx4 v1, s[56:59], s91 offen offset:0 sc1 lds
    buffer_load_dwordx4 v1, s[56:59], s91 offen offset:1024 sc1 lds
    s_add_u32 m0, s73, 2048
    s_add_u32 s91, s72, 6144
    buffer_load_dwordx4 v1, s[56:59], s91 offen offset:0 sc1 lds
    buffer_load_dwordx4 v1, s[56:59], s91 offen offset:1024 sc1 lds
    s_add_u32 m0, s73, 16384
    s_add_u32 s91, s72, 264192
    buffer_load_dwordx4 v1, s[56:59], s91 offen offset:0 sc1 lds
    buffer_load_dwordx4 v1, s[56:59], s91 offen offset:1024 sc1 lds
    s_add_u32 m0, s73, 18432
    s_add_u32 s91, s72, 268288
    buffer_load_dwordx4 v1, s[56:59], s91 offen offset:0 sc1 lds
    buffer_load_dwordx4 v1, s[56:59], s91 offen offset:1024 sc1 lds
Lhf_18:
    ds_read_b128 v[16:19], v2
    ds_read_b128 v[20:23], v2 offset:1024
    s_waitcnt lgkmcnt(0)
    s_add_u32 s95, s85, 1
    v_mfma_f32_32x32x16_bf16 v[120:135], v[56:59], v[16:19], v[40:55]
    v_mfma_f32_32x32x16_bf16 v[120:135], v[60:63], v[20:23], v[120:135]
    s_cmp_gt_u32 s95, 1
    s_cbranch_scc0 Lh_22
    v_mfma_f32_32x32x16_bf16 v[136:151], v[72:75], v[16:19], 0
    v_mfma_f32_32x32x16_bf16 v[136:151], v[76:79], v[20:23], v[136:151]
    s_nop 7
    v_max_f32 v4, v120, v121
    v_max_f32 v5, v122, v123
    v_max3_f32 v4, v4, v124, v125
    v_max3_f32 v5, v5, v126, v127
    v_max3_f32 v4, v4, v128, v129
    v_max3_f32 v5, v5, v130, v131
    v_max3_f32 v4, v4, v132, v133
    v_max3_f32 v5, v5, v134, v135
    v_max3_f32 v4, v4, v136, v137
    v_max3_f32 v5, v5, v138, v139
    v_max3_f32 v4, v4, v140, v141
    v_max3_f32 v5, v5, v142, v143
    v_max3_f32 v4, v4, v144, v145
    v_max3_f32 v5, v5, v146, v147
    v_max3_f32 v4, v4, v148, v149
    v_max3_f32 v5, v5, v150, v151
    s_branch Lh_23
Lh_22:
    s_nop 9
    v_max_f32 v4, v120, v121
    v_max_f32 v5, v122, v123
    v_max3_f32 v4, v4, v124, v125
    v_max3_f32 v5, v5, v126, v127
    v_max3_f32 v4, v4, v128, v129
    v_max3_f32 v5, v5, v130, v131
    v_max3_f32 v4, v4, v132, v133
    v_max3_f32 v5, v5, v134, v135
Lh_23:
    v_max_f32 v4, v4, v5
    v_mov_b32 v5, v4
    s_nop 1
    v_permlane32_swap_b32 v4, v5
    v_max_f32 v4, v4, v5
    v_sub_f32 v120, v40, v4
    v_sub_f32 v121, v41, v4
    v_sub_f32 v122, v42, v4
    v_sub_f32 v123, v43, v4
    v_sub_f32 v124, v44, v4
    v_sub_f32 v125, v45, v4
    v_sub_f32 v126, v46, v4
    v_sub_f32 v127, v47, v4
    v_sub_f32 v128, v48, v4
    v_sub_f32 v129, v49, v4
    v_sub_f32 v130, v50, v4
    v_sub_f32 v131, v51, v4
    v_sub_f32 v132, v52, v4
    v_sub_f32 v133, v53, v4
    v_sub_f32 v134, v54, v4
    v_sub_f32 v135, v55, v4
    v_mov_b32 v12, v4
    v_sub_f32 v168, 0, v4
    v_mfma_f32_32x32x16_bf16 v[120:135], v[56:59], v[16:19], v[120:135]
    v_mov_b32 v169, v168
    v_mov_b32 v170, v168
    v_mov_b32 v171, v168
    v_mov_b32 v172, v168
    v_mov_b32 v173, v168
    v_mfma_f32_32x32x16_bf16 v[120:135], v[60:63], v[20:23], v[120:135]
    v_mov_b32 v174, v168
    v_mov_b32 v175, v168
    v_mov_b32 v176, v168
    v_mov_b32 v177, v168
    v_mov_b32 v178, v168
    v_mov_b32 v179, v168
    v_mov_b32 v180, v168
    v_mov_b32 v181, v168
    v_mov_b32 v182, v168
    v_mov_b32 v183, v168
    s_nop 1
    v_exp_f32 v120, v120
    v_exp_f32 v121, v121
    v_exp_f32 v122, v122
    v_exp_f32 v123, v123
    v_exp_f32 v124, v124
    v_mfma_f32_32x32x16_bf16 v[136:151], v[72:75], v[16:19], v[168:183]
    v_exp_f32 v125, v125
    v_exp_f32 v126, v126
    v_exp_f32 v127, v127
    v_cvt_pk_bf16_f32 v120, v120, v121
    v_cvt_pk_bf16_f32 v121, v122, v123
    v_cvt_pk_bf16_f32 v122, v124, v125
    v_cvt_pk_bf16_f32 v123, v126, v127
    v_mfma_f32_32x32x16_bf16 v[136:151], v[76:79], v[20:23], v[136:151]
    v_exp_f32 v128, v128
    v_exp_f32 v129, v129
    v_exp_f32 v130, v130
    v_mfma_f32_32x32x16_bf16 v[24:39], v[64:67], v[120:123], 0
    v_exp_f32 v131, v131
    v_exp_f32 v132, v132
    v_exp_f32 v133, v133
    v_mfma_f32_16x16x32_bf16 v[8:11], v[236:239], v[120:123], 0
    v_exp_f32 v134, v134
    v_exp_f32 v135, v135
    v_cvt_pk_bf16_f32 v128, v128, v129
    v_cvt_pk_bf16_f32 v129, v130, v131
    v_cvt_pk_bf16_f32 v130, v132, v133
    v_cvt_pk_bf16_f32 v131, v134, v135
    s_cmp_gt_u32 s95, 1
    s_cbranch_scc0 Lh_24
    v_exp_f32 v136, v136
    v_exp_f32 v137, v137
    v_mfma_f32_32x32x16_bf16 v[24:39], v[68:71], v[128:131], v[24:39]
    v_exp_f32 v138, v138
    v_exp_f32 v139, v139
    v_exp_f32 v140, v140
    v_exp_f32 v141, v141
    v_exp_f32 v142, v142
    v_mfma_f32_16x16x32_bf16 v[8:11], v[236:239], v[128:131], v[8:11]
    v_exp_f32 v143, v143
    v_cvt_pk_bf16_f32 v136, v136, v137
    v_cvt_pk_bf16_f32 v137, v138, v139
    v_cvt_pk_bf16_f32 v138, v140, v141
    v_cvt_pk_bf16_f32 v139, v142, v143
    v_exp_f32 v144, v144
    v_exp_f32 v145, v145
    v_exp_f32 v146, v146
    v_mfma_f32_32x32x16_bf16 v[24:39], v[80:83], v[136:139], v[24:39]
    v_exp_f32 v147, v147
    v_exp_f32 v148, v148
    v_exp_f32 v149, v149
    v_mfma_f32_16x16x32_bf16 v[8:11], v[236:239], v[136:139], v[8:11]
    v_exp_f32 v150, v150
    v_exp_f32 v151, v151
    v_cvt_pk_bf16_f32 v144, v144, v145
    v_cvt_pk_bf16_f32 v145, v146, v147
    v_cvt_pk_bf16_f32 v146, v148, v149
    v_cvt_pk_bf16_f32 v147, v150, v151
    s_nop 1
    v_mfma_f32_32x32x16_bf16 v[24:39], v[84:87], v[144:147], v[24:39]
    v_mfma_f32_16x16x32_bf16 v[8:11], v[236:239], v[144:147], v[8:11]
    s_branch Lh_25
Lh_24:
    v_mfma_f32_32x32x16_bf16 v[24:39], v[68:71], v[128:131], v[24:39]
    v_mfma_f32_16x16x32_bf16 v[8:11], v[236:239], v[128:131], v[8:11]
Lh_25:
    s_cmp_eq_u32 s82, 1
    s_cselect_b32 s90, 4, s85
    s_cselect_b32 s92, 0, -1
    s_sub_u32 s95, 8, s90
    s_lshl_b32 s91, s84, 14
    v_add_u32 v3, s91, v1
    s_lshl_b32 s90, s90, 11
    v_add_u32 v2, s90, v3
    s_and_b32 s92, s92, 0xff800000
    v_bfi_b32 v40, v40, 0, s92
    v_bfi_b32 v41, v41, 0, s92
    v_bfi_b32 v42, v42, 0, s92
    v_bfi_b32 v43, v43, 0, s92
    v_bfi_b32 v44, v44, 0, s92
    v_bfi_b32 v45, v45, 0, s92
    v_bfi_b32 v46, v46, 0, s92
    v_bfi_b32 v47, v47, 0, s92
    v_bfi_b32 v48, v48, 0, s92
    v_bfi_b32 v49, v49, 0, s92
    v_bfi_b32 v50, v50, 0, s92
    v_bfi_b32 v51, v51, 0, s92
    v_bfi_b32 v52, v52, 0, s92
    v_bfi_b32 v53, v53, 0, s92
    v_bfi_b32 v54, v54, 0, s92
    v_bfi_b32 v55, v55, 0, s92
    v_lshrrev_b32 v14, 3, v0
    v_lshrrev_b32 v15, 4, v0
    v_lshlrev_b32 v15, 1, v15
    v_and_b32 v248, 7, v0
    v_xor_b32 v15, v15, v248
    v_lshlrev_b32 v15, 4, v15
    v_lshl_add_u32 v14, v14, 11, v15
    s_lshl_b32 s90, s78, 7
    v_add_u32 v14, s90, v14
    v_add_u32 v15, 15360, v14
    v_and_b32 v6, 16, v0
    v_lshlrev_b32 v6, 11, v6
    v_and_b32 v7, 15, v0
    v_lshl_add_u32 v6, v7, 4, v6
    v_and_b32 v7, 32, v0
    v_lshl_add_u32 v6, v7, 3, v6
    s_add_u32 s90, s87, s85
    s_lshl_b32 s91, s90, 16
    s_lshl_b32 s92, s86, 10
    s_add_u32 s91, s91, s92
    s_add_u32 s91, s91, 0x800000
    v_add_u32 v6, s91, v6
    s_waitcnt lgkmcnt(0)
    s_barrier
    buffer_store_dwordx4 v[200:203], v244, s[56:59], s66 offen offset:0 sc1
    buffer_store_dwordx4 v[204:207], v244, s[56:59], s66 offen offset:2048 sc1
    buffer_store_dwordx4 v[208:211], v244, s[56:59], s67 offen offset:0 sc1
    buffer_store_dwordx4 v[212:215], v244, s[56:59], s67 offen offset:2048 sc1
    s_waitcnt vmcnt(4)
    s_barrier
    s_branch L_att
L_compute:
    s_load_dwordx4 s[8:11], s[0:1], 16
    s_load_dwordx4 s[12:15], s[0:1], 48
    s_load_dwordx2 s[16:17], s[0:1], 64
    s_load_dwordx2 s[24:25], s[0:1], 80
    v_lshlrev_b32 v1, 4, v0
    v_mov_b32 v244, 0
    v_mov_b32 v252, 0
    s_lshr_b32 s84, s3, 1
    s_and_b32 s84, s84, 1
    s_and_b32 s90, s3, 1
    s_sub_u32 s91, 3, s90
    s_cmp_lt_u32 s3, 4
    s_cselect_b32 s85, s91, s90
    s_lshl_b32 s86, s83, 1
    s_add_u32 s86, s86, s84
    s_lshl_b32 s87, s82, 2
    s_mov_b32 s88, 0x3e8293ee
    s_and_b32 s90, s80, 3
    s_lshl_b32 s90, s90, 2
    s_and_b32 s91, s81, 3
    s_add_u32 s79, s90, s91
    s_lshr_b32 s90, s80, 2
    s_lshl_b32 s90, s90, 3
    s_lshr_b32 s91, s81, 2
    s_add_u32 s78, s90, s91
    v_mov_b32 v39, 0xff800000
    s_mov_b32 s90, 0xffffffff
    s_mov_b32 s91, 0xfffffff0
    v_cndmask_b32 v40, v39, 0, s[90:91]
    s_mov_b32 s90, 0xfffffffe
    s_mov_b32 s91, 0xffffffe0
    v_cndmask_b32 v41, v39, 0, s[90:91]
    s_mov_b32 s90, 0xfffffffc
    s_mov_b32 s91, 0xffffffc0
    v_cndmask_b32 v42, v39, 0, s[90:91]
    s_mov_b32 s90, 0xfffffff8
    s_mov_b32 s91, 0xffffff80
    v_cndmask_b32 v43, v39, 0, s[90:91]
    s_mov_b32 s90, 0xffff0000
    s_mov_b32 s91, 0xfff00000
    v_cndmask_b32 v44, v39, 0, s[90:91]
    s_mov_b32 s90, 0xfffe0000
    s_mov_b32 s91, 0xffe00000
    v_cndmask_b32 v45, v39, 0, s[90:91]
    s_mov_b32 s90, 0xfffc0000
    s_mov_b32 s91, 0xffc00000
    v_cndmask_b32 v46, v39, 0, s[90:91]
    s_mov_b32 s90, 0xfff80000
    s_mov_b32 s91, 0xff800000
    v_cndmask_b32 v47, v39, 0, s[90:91]
    s_mov_b32 s90, 0xffffff00
    s_mov_b32 s91, 0xfffff000
    v_cndmask_b32 v48, v39, 0, s[90:91]
    s_mov_b32 s90, 0xfffffe00
    s_mov_b32 s91, 0xffffe000
    v_cndmask_b32 v49, v39, 0, s[90:91]
    s_mov_b32 s90, 0xfffffc00
    s_mov_b32 s91, 0xffffc000
    v_cndmask_b32 v50, v39, 0, s[90:91]
    s_mov_b32 s90, 0xfffff800
    s_mov_b32 s91, 0xffff8000
    v_cndmask_b32 v51, v39, 0, s[90:91]
    s_mov_b32 s90, 0xff000000
    s_mov_b32 s91, 0xf0000000
    v_cndmask_b32 v52, v39, 0, s[90:91]
    s_mov_b32 s90, 0xfe000000
    s_mov_b32 s91, 0xe0000000
    v_cndmask_b32 v53, v39, 0, s[90:91]
    s_mov_b32 s90, 0xfc000000
    s_mov_b32 s91, 0xc0000000
    v_cndmask_b32 v54, v39, 0, s[90:91]
    s_mov_b32 s90, 0xf8000000
    s_mov_b32 s91, 0x80000000
    v_cndmask_b32 v55, v39, 0, s[90:91]
    v_mov_b32 v39, 0x3f803f80
    s_mov_b32 s90, 0x10100101
    s_mov_b32 s91, 0x10100101
    v_cndmask_b32 v236, 0, v39, s[90:91]
    v_cndmask_b32 v237, 0, v39, s[90:91]
    v_cndmask_b32 v238, 0, v39, s[90:91]
    v_cndmask_b32 v239, 0, v39, s[90:91]
    s_waitcnt lgkmcnt(0)
    s_mov_b32 s36, s8
    s_and_b32 s37, s9, 0xffff
    s_mov_b32 s38, 0x200000
    s_mov_b32 s39, 0x20000
    s_mov_b32 s40, s10
    s_and_b32 s41, s11, 0xffff
    s_mov_b32 s42, 0x400000
    s_mov_b32 s43, 0x20000
    s_mov_b32 s44, s12
    s_and_b32 s45, s13, 0xffff
    s_mov_b32 s46, 0x200000
    s_mov_b32 s47, 0x20000
    s_mov_b32 s48, s14
    s_and_b32 s49, s15, 0xffff
    s_mov_b32 s50, 0x200000
    s_mov_b32 s51, 0x20000
    s_mov_b32 s52, s16
    s_and_b32 s53, s17, 0xffff
    s_mov_b32 s54, 0x800000
    s_mov_b32 s55, 0x20000
    s_mov_b32 s56, s24
    s_and_b32 s57, s25, 0xffff
    s_mov_b32 s58, 0x1100000
    s_mov_b32 s59, 0x20000
    s_add_u32 s70, s24, 0x10a0000
    s_addc_u32 s71, s25, 0
    s_and_b32 s18, s81, 15
    s_xor_b32 s18, s18, 0
    s_lshl_b32 s18, s18, 1
    s_lshr_b32 s90, s81, 4
    s_add_u32 s18, s18, s90
    s_and_b32 s94, s3, 1
    s_lshr_b32 s95, s3, 1
    v_and_b32 v16, 15, v0
    v_lshrrev_b32 v17, 4, v0
    v_lshrrev_b32 v18, 1, v16
    v_xor_b32 v18, v18, v17
    v_lshlrev_b32 v18, 4, v18
    v_lshl_add_u32 v2, v16, 7, v18
    s_lshl_b32 s90, s94, 13
    v_add_u32 v2, s90, v2
    v_xor_b32 v3, 64, v2
    v_lshrrev_b32 v18, 2, v0
    v_and_b32 v18, 3, v18
    v_lshrrev_b32 v19, 1, v18
    v_and_b32 v20, 1, v17
    v_lshl_add_u32 v19, v20, 1, v19
    s_lshl_b32 s90, s95, 1
    v_xor_b32 v19, s90, v19
    v_lshlrev_b32 v19, 5, v19
    v_lshl_add_u32 v4, v18, 7, v19
    v_lshl_add_u32 v4, v20, 10, v4
    v_lshrrev_b32 v20, 1, v17
    v_mul_u32_u24 v20, 6144, v20
    v_add_u32 v4, v4, v20
    v_and_b32 v18, 3, v0
    v_lshl_add_u32 v4, v18, 3, v4
    v_add_u32 v4, 16384, v4
    v_xor_b32 v5, 32, v4
    v_add_u32 v6, 40960, v2
    v_add_u32 v7, 40960, v3
    v_add_u32 v8, 40960, v4
    v_add_u32 v9, 40960, v5
    v_add_u32 v10, 81920, v2
    v_add_u32 v11, 81920, v3
    v_add_u32 v12, 81920, v4
    v_add_u32 v13, 81920, v5
    v_lshlrev_b32 v17, 9, v17
    v_lshl_add_u32 v22, v16, 4, v17
    v_and_b32 v18, 8, v0
    v_lshl_add_u32 v21, v18, 4, v22
    s_lshl_b32 s91, s3, 13
    s_lshl_b32 s92, s3, 12
    s_add_u32 s92, s92, 122880
    v_add_u32 v233, s91, v22
    v_add_u32 v232, s91, v21
    v_add_u32 v234, s92, v22
    v_mov_b32 v136, 0
    v_mov_b32 v137, 0
    v_mov_b32 v138, 0
    v_mov_b32 v139, 0
    v_mov_b32 v140, 0
    v_mov_b32 v141, 0
    v_mov_b32 v142, 0
    v_mov_b32 v143, 0
    v_mov_b32 v144, 0
    v_mov_b32 v145, 0
    v_mov_b32 v146, 0
    v_mov_b32 v147, 0
    v_mov_b32 v148, 0
    v_mov_b32 v149, 0
    v_mov_b32 v150, 0
    v_mov_b32 v151, 0
    v_mov_b32 v152, 0
    v_mov_b32 v153, 0
    v_mov_b32 v154, 0
    v_mov_b32 v155, 0
    v_mov_b32 v156, 0
    v_mov_b32 v157, 0
    v_mov_b32 v158, 0
    v_mov_b32 v159, 0
    v_mov_b32 v160, 0
    v_mov_b32 v161, 0
    v_mov_b32 v162, 0
    v_mov_b32 v163, 0
    v_mov_b32 v164, 0
    v_mov_b32 v165, 0
    v_mov_b32 v166, 0
    v_mov_b32 v167, 0
    v_mov_b32 v168, 0
    v_mov_b32 v169, 0
    v_mov_b32 v170, 0
    v_mov_b32 v171, 0
    v_mov_b32 v172, 0
    v_mov_b32 v173, 0
    v_mov_b32 v174, 0
    v_mov_b32 v175, 0
    v_mov_b32 v176, 0
    v_mov_b32 v177, 0
    v_mov_b32 v178, 0
    v_mov_b32 v179, 0
    v_mov_b32 v180, 0
    v_mov_b32 v181, 0
    v_mov_b32 v182, 0
    v_mov_b32 v183, 0
    v_mov_b32 v184, 0
    v_mov_b32 v185, 0
    v_mov_b32 v186, 0
    v_mov_b32 v187, 0
    v_mov_b32 v188, 0
    v_mov_b32 v189, 0
    v_mov_b32 v190, 0
    v_mov_b32 v191, 0
    v_mov_b32 v192, 0
    v_mov_b32 v193, 0
    v_mov_b32 v194, 0
    v_mov_b32 v195, 0
    v_mov_b32 v196, 0
    v_mov_b32 v197, 0
    v_mov_b32 v198, 0
    v_mov_b32 v199, 0
    v_mov_b32 v200, 0
    v_mov_b32 v201, 0
    v_mov_b32 v202, 0
    v_mov_b32 v203, 0
    v_mov_b32 v204, 0
    v_mov_b32 v205, 0
    v_mov_b32 v206, 0
    v_mov_b32 v207, 0
    v_mov_b32 v208, 0
    v_mov_b32 v209, 0
    v_mov_b32 v210, 0
    v_mov_b32 v211, 0
    v_mov_b32 v212, 0
    v_mov_b32 v213, 0
    v_mov_b32 v214, 0
    v_mov_b32 v215, 0
    v_mov_b32 v216, 0
    v_mov_b32 v217, 0
    v_mov_b32 v218, 0
    v_mov_b32 v219, 0
    v_mov_b32 v220, 0
    v_mov_b32 v221, 0
    v_mov_b32 v222, 0
    v_mov_b32 v223, 0
    v_mov_b32 v224, 0
    v_mov_b32 v225, 0
    v_mov_b32 v226, 0
    v_mov_b32 v227, 0
    v_mov_b32 v228, 0
    v_mov_b32 v229, 0
    v_mov_b32 v230, 0
    v_mov_b32 v231, 0
    s_mov_b32 s93, 0
    s_barrier
    ds_read_b128 v[56:59], v10 offset:0
    ds_read_b128 v[60:63], v10 offset:2048
    ds_read_b128 v[64:67], v10 offset:4096
    ds_read_b128 v[68:71], v10 offset:6144
    ds_read_b64_tr_b16 v[72:73], v12 offset:0
    ds_read_b64_tr_b16 v[74:75], v12 offset:512
    ds_read_b64_tr_b16 v[76:77], v13 offset:0
    ds_read_b64_tr_b16 v[78:79], v13 offset:512
    ds_read_b64_tr_b16 v[80:81], v12 offset:2048
    ds_read_b64_tr_b16 v[82:83], v12 offset:2560
    ds_read_b64_tr_b16 v[84:85], v13 offset:2048
    ds_read_b64_tr_b16 v[86:87], v13 offset:2560
    ds_read_b64_tr_b16 v[88:89], v12 offset:4096
    ds_read_b64_tr_b16 v[90:91], v12 offset:4608
    ds_read_b64_tr_b16 v[92:93], v13 offset:4096
    ds_read_b64_tr_b16 v[94:95], v13 offset:4608
    s_branch L_g1mid
L_g1loop:
    s_waitcnt lgkmcnt(0)
    v_mfma_f32_16x16x32_bf16 v[136:139], v[72:75], v[56:59], v[136:139]
    ds_read_b128 v[96:99], v7 offset:0
    v_mfma_f32_16x16x32_bf16 v[140:143], v[76:79], v[56:59], v[140:143]
    ds_read_b128 v[100:103], v7 offset:2048
    v_mfma_f32_16x16x32_bf16 v[144:147], v[80:83], v[56:59], v[144:147]
    ds_read_b128 v[104:107], v7 offset:4096
    v_mfma_f32_16x16x32_bf16 v[148:151], v[84:87], v[56:59], v[148:151]
    ds_read_b128 v[108:111], v7 offset:6144
    v_mfma_f32_16x16x32_bf16 v[152:155], v[56:59], v[88:91], v[152:155]
    ds_read_b64_tr_b16 v[112:113], v8 offset:12288
    v_mfma_f32_16x16x32_bf16 v[156:159], v[56:59], v[92:95], v[156:159]
    ds_read_b64_tr_b16 v[114:115], v8 offset:12800
    v_mfma_f32_16x16x32_bf16 v[160:163], v[72:75], v[60:63], v[160:163]
    ds_read_b64_tr_b16 v[116:117], v9 offset:12288
    v_mfma_f32_16x16x32_bf16 v[164:167], v[76:79], v[60:63], v[164:167]
    ds_read_b64_tr_b16 v[118:119], v9 offset:12800
    v_mfma_f32_16x16x32_bf16 v[168:171], v[80:83], v[60:63], v[168:171]
    ds_read_b64_tr_b16 v[120:121], v8 offset:14336
    v_mfma_f32_16x16x32_bf16 v[172:175], v[84:87], v[60:63], v[172:175]
    ds_read_b64_tr_b16 v[122:123], v8 offset:14848
    v_mfma_f32_16x16x32_bf16 v[176:179], v[60:63], v[88:91], v[176:179]
    ds_read_b64_tr_b16 v[124:125], v9 offset:14336
    v_mfma_f32_16x16x32_bf16 v[180:183], v[60:63], v[92:95], v[180:183]
    ds_read_b64_tr_b16 v[126:127], v9 offset:14848
    v_mfma_f32_16x16x32_bf16 v[184:187], v[72:75], v[64:67], v[184:187]
    ds_read_b64_tr_b16 v[128:129], v8 offset:16384
    v_mfma_f32_16x16x32_bf16 v[188:191], v[76:79], v[64:67], v[188:191]
    ds_read_b64_tr_b16 v[130:131], v8 offset:16896
    v_mfma_f32_16x16x32_bf16 v[192:195], v[80:83], v[64:67], v[192:195]
    ds_read_b64_tr_b16 v[132:133], v9 offset:16384
    v_mfma_f32_16x16x32_bf16 v[196:199], v[84:87], v[64:67], v[196:199]
    ds_read_b64_tr_b16 v[134:135], v9 offset:16896
    v_mfma_f32_16x16x32_bf16 v[200:203], v[64:67], v[88:91], v[200:203]
    v_mfma_f32_16x16x32_bf16 v[204:207], v[64:67], v[92:95], v[204:207]
    v_mfma_f32_16x16x32_bf16 v[208:211], v[72:75], v[68:71], v[208:211]
    v_mfma_f32_16x16x32_bf16 v[212:215], v[76:79], v[68:71], v[212:215]
    v_mfma_f32_16x16x32_bf16 v[216:219], v[80:83], v[68:71], v[216:219]
    v_mfma_f32_16x16x32_bf16 v[220:223], v[84:87], v[68:71], v[220:223]
    v_mfma_f32_16x16x32_bf16 v[224:227], v[68:71], v[88:91], v[224:227]
    v_mfma_f32_16x16x32_bf16 v[228:231], v[68:71], v[92:95], v[228:231]
    s_waitcnt lgkmcnt(0)
    s_barrier
    v_mfma_f32_16x16x32_bf16 v[136:139], v[112:115], v[96:99], v[136:139]
    ds_read_b128 v[56:59], v10 offset:0
    v_mfma_f32_16x16x32_bf16 v[140:143], v[116:119], v[96:99], v[140:143]
    ds_read_b128 v[60:63], v10 offset:2048
    v_mfma_f32_16x16x32_bf16 v[144:147], v[120:123], v[96:99], v[144:147]
    ds_read_b128 v[64:67], v10 offset:4096
    v_mfma_f32_16x16x32_bf16 v[148:151], v[124:127], v[96:99], v[148:151]
    ds_read_b128 v[68:71], v10 offset:6144
    v_mfma_f32_16x16x32_bf16 v[152:155], v[96:99], v[128:131], v[152:155]
    ds_read_b64_tr_b16 v[72:73], v12 offset:0
    v_mfma_f32_16x16x32_bf16 v[156:159], v[96:99], v[132:135], v[156:159]
    ds_read_b64_tr_b16 v[74:75], v12 offset:512
    v_mfma_f32_16x16x32_bf16 v[160:163], v[112:115], v[100:103], v[160:163]
    ds_read_b64_tr_b16 v[76:77], v13 offset:0
    v_mfma_f32_16x16x32_bf16 v[164:167], v[116:119], v[100:103], v[164:167]
    ds_read_b64_tr_b16 v[78:79], v13 offset:512
    v_mfma_f32_16x16x32_bf16 v[168:171], v[120:123], v[100:103], v[168:171]
    ds_read_b64_tr_b16 v[80:81], v12 offset:2048
    v_mfma_f32_16x16x32_bf16 v[172:175], v[124:127], v[100:103], v[172:175]
    ds_read_b64_tr_b16 v[82:83], v12 offset:2560
    v_mfma_f32_16x16x32_bf16 v[176:179], v[100:103], v[128:131], v[176:179]
    ds_read_b64_tr_b16 v[84:85], v13 offset:2048
    v_mfma_f32_16x16x32_bf16 v[180:183], v[100:103], v[132:135], v[180:183]
    ds_read_b64_tr_b16 v[86:87], v13 offset:2560
    v_mfma_f32_16x16x32_bf16 v[184:187], v[112:115], v[104:107], v[184:187]
    ds_read_b64_tr_b16 v[88:89], v12 offset:4096
    v_mfma_f32_16x16x32_bf16 v[188:191], v[116:119], v[104:107], v[188:191]
    ds_read_b64_tr_b16 v[90:91], v12 offset:4608
    v_mfma_f32_16x16x32_bf16 v[192:195], v[120:123], v[104:107], v[192:195]
    ds_read_b64_tr_b16 v[92:93], v13 offset:4096
    v_mfma_f32_16x16x32_bf16 v[196:199], v[124:127], v[104:107], v[196:199]
    ds_read_b64_tr_b16 v[94:95], v13 offset:4608
    v_mfma_f32_16x16x32_bf16 v[200:203], v[104:107], v[128:131], v[200:203]
    v_mfma_f32_16x16x32_bf16 v[204:207], v[104:107], v[132:135], v[204:207]
    v_mfma_f32_16x16x32_bf16 v[208:211], v[112:115], v[108:111], v[208:211]
    v_mfma_f32_16x16x32_bf16 v[212:215], v[116:119], v[108:111], v[212:215]
    v_mfma_f32_16x16x32_bf16 v[216:219], v[120:123], v[108:111], v[216:219]
    v_mfma_f32_16x16x32_bf16 v[220:223], v[124:127], v[108:111], v[220:223]
    v_mfma_f32_16x16x32_bf16 v[224:227], v[108:111], v[128:131], v[224:227]
    v_mfma_f32_16x16x32_bf16 v[228:231], v[108:111], v[132:135], v[228:231]
L_g1mid:
    s_waitcnt lgkmcnt(0)
    v_mfma_f32_16x16x32_bf16 v[136:139], v[72:75], v[56:59], v[136:139]
    ds_read_b128 v[96:99], v11 offset:0
    v_mfma_f32_16x16x32_bf16 v[140:143], v[76:79], v[56:59], v[140:143]
    ds_read_b128 v[100:103], v11 offset:2048
    v_mfma_f32_16x16x32_bf16 v[144:147], v[80:83], v[56:59], v[144:147]
    ds_read_b128 v[104:107], v11 offset:4096
    v_mfma_f32_16x16x32_bf16 v[148:151], v[84:87], v[56:59], v[148:151]
    ds_read_b128 v[108:111], v11 offset:6144
    v_mfma_f32_16x16x32_bf16 v[152:155], v[56:59], v[88:91], v[152:155]
    ds_read_b64_tr_b16 v[112:113], v12 offset:12288
    v_mfma_f32_16x16x32_bf16 v[156:159], v[56:59], v[92:95], v[156:159]
    ds_read_b64_tr_b16 v[114:115], v12 offset:12800
    v_mfma_f32_16x16x32_bf16 v[160:163], v[72:75], v[60:63], v[160:163]
    ds_read_b64_tr_b16 v[116:117], v13 offset:12288
    v_mfma_f32_16x16x32_bf16 v[164:167], v[76:79], v[60:63], v[164:167]
    ds_read_b64_tr_b16 v[118:119], v13 offset:12800
    v_mfma_f32_16x16x32_bf16 v[168:171], v[80:83], v[60:63], v[168:171]
    ds_read_b64_tr_b16 v[120:121], v12 offset:14336
    v_mfma_f32_16x16x32_bf16 v[172:175], v[84:87], v[60:63], v[172:175]
    ds_read_b64_tr_b16 v[122:123], v12 offset:14848
    v_mfma_f32_16x16x32_bf16 v[176:179], v[60:63], v[88:91], v[176:179]
    ds_read_b64_tr_b16 v[124:125], v13 offset:14336
    v_mfma_f32_16x16x32_bf16 v[180:183], v[60:63], v[92:95], v[180:183]
    ds_read_b64_tr_b16 v[126:127], v13 offset:14848
    v_mfma_f32_16x16x32_bf16 v[184:187], v[72:75], v[64:67], v[184:187]
    ds_read_b64_tr_b16 v[128:129], v12 offset:16384
    v_mfma_f32_16x16x32_bf16 v[188:191], v[76:79], v[64:67], v[188:191]
    ds_read_b64_tr_b16 v[130:131], v12 offset:16896
    v_mfma_f32_16x16x32_bf16 v[192:195], v[80:83], v[64:67], v[192:195]
    ds_read_b64_tr_b16 v[132:133], v13 offset:16384
    v_mfma_f32_16x16x32_bf16 v[196:199], v[84:87], v[64:67], v[196:199]
    ds_read_b64_tr_b16 v[134:135], v13 offset:16896
    v_mfma_f32_16x16x32_bf16 v[200:203], v[64:67], v[88:91], v[200:203]
    v_mfma_f32_16x16x32_bf16 v[204:207], v[64:67], v[92:95], v[204:207]
    v_mfma_f32_16x16x32_bf16 v[208:211], v[72:75], v[68:71], v[208:211]
    v_mfma_f32_16x16x32_bf16 v[212:215], v[76:79], v[68:71], v[212:215]
    v_mfma_f32_16x16x32_bf16 v[216:219], v[80:83], v[68:71], v[216:219]
    v_mfma_f32_16x16x32_bf16 v[220:223], v[84:87], v[68:71], v[220:223]
    v_mfma_f32_16x16x32_bf16 v[224:227], v[68:71], v[88:91], v[224:227]
    v_mfma_f32_16x16x32_bf16 v[228:231], v[68:71], v[92:95], v[228:231]
    s_waitcnt lgkmcnt(0)
    s_barrier
    v_mfma_f32_16x16x32_bf16 v[136:139], v[112:115], v[96:99], v[136:139]
    ds_read_b128 v[56:59], v2 offset:0
    v_mfma_f32_16x16x32_bf16 v[140:143], v[116:119], v[96:99], v[140:143]
    ds_read_b128 v[60:63], v2 offset:2048
    v_mfma_f32_16x16x32_bf16 v[144:147], v[120:123], v[96:99], v[144:147]
    ds_read_b128 v[64:67], v2 offset:4096
    v_mfma_f32_16x16x32_bf16 v[148:151], v[124:127], v[96:99], v[148:151]
    ds_read_b128 v[68:71], v2 offset:6144
    v_mfma_f32_16x16x32_bf16 v[152:155], v[96:99], v[128:131], v[152:155]
    ds_read_b64_tr_b16 v[72:73], v4 offset:0
    v_mfma_f32_16x16x32_bf16 v[156:159], v[96:99], v[132:135], v[156:159]
    ds_read_b64_tr_b16 v[74:75], v4 offset:512
    v_mfma_f32_16x16x32_bf16 v[160:163], v[112:115], v[100:103], v[160:163]
    ds_read_b64_tr_b16 v[76:77], v5 offset:0
    v_mfma_f32_16x16x32_bf16 v[164:167], v[116:119], v[100:103], v[164:167]
    ds_read_b64_tr_b16 v[78:79], v5 offset:512
    v_mfma_f32_16x16x32_bf16 v[168:171], v[120:123], v[100:103], v[168:171]
    ds_read_b64_tr_b16 v[80:81], v4 offset:2048
    v_mfma_f32_16x16x32_bf16 v[172:175], v[124:127], v[100:103], v[172:175]
    ds_read_b64_tr_b16 v[82:83], v4 offset:2560
    v_mfma_f32_16x16x32_bf16 v[176:179], v[100:103], v[128:131], v[176:179]
    ds_read_b64_tr_b16 v[84:85], v5 offset:2048
    v_mfma_f32_16x16x32_bf16 v[180:183], v[100:103], v[132:135], v[180:183]
    ds_read_b64_tr_b16 v[86:87], v5 offset:2560
    v_mfma_f32_16x16x32_bf16 v[184:187], v[112:115], v[104:107], v[184:187]
    ds_read_b64_tr_b16 v[88:89], v4 offset:4096
    v_mfma_f32_16x16x32_bf16 v[188:191], v[116:119], v[104:107], v[188:191]
    ds_read_b64_tr_b16 v[90:91], v4 offset:4608
    v_mfma_f32_16x16x32_bf16 v[192:195], v[120:123], v[104:107], v[192:195]
    ds_read_b64_tr_b16 v[92:93], v5 offset:4096
    v_mfma_f32_16x16x32_bf16 v[196:199], v[124:127], v[104:107], v[196:199]
    ds_read_b64_tr_b16 v[94:95], v5 offset:4608
    v_mfma_f32_16x16x32_bf16 v[200:203], v[104:107], v[128:131], v[200:203]
    v_mfma_f32_16x16x32_bf16 v[204:207], v[104:107], v[132:135], v[204:207]
    v_mfma_f32_16x16x32_bf16 v[208:211], v[112:115], v[108:111], v[208:211]
    v_mfma_f32_16x16x32_bf16 v[212:215], v[116:119], v[108:111], v[212:215]
    v_mfma_f32_16x16x32_bf16 v[216:219], v[120:123], v[108:111], v[216:219]
    v_mfma_f32_16x16x32_bf16 v[220:223], v[124:127], v[108:111], v[220:223]
    v_mfma_f32_16x16x32_bf16 v[224:227], v[108:111], v[128:131], v[224:227]
    v_mfma_f32_16x16x32_bf16 v[228:231], v[108:111], v[132:135], v[228:231]
    s_waitcnt lgkmcnt(0)
    v_mfma_f32_16x16x32_bf16 v[136:139], v[72:75], v[56:59], v[136:139]
    ds_read_b128 v[96:99], v3 offset:0
    v_mfma_f32_16x16x32_bf16 v[140:143], v[76:79], v[56:59], v[140:143]
    ds_read_b128 v[100:103], v3 offset:2048
    v_mfma_f32_16x16x32_bf16 v[144:147], v[80:83], v[56:59], v[144:147]
    ds_read_b128 v[104:107], v3 offset:4096
    v_mfma_f32_16x16x32_bf16 v[148:151], v[84:87], v[56:59], v[148:151]
    ds_read_b128 v[108:111], v3 offset:6144
    v_mfma_f32_16x16x32_bf16 v[152:155], v[56:59], v[88:91], v[152:155]
    ds_read_b64_tr_b16 v[112:113], v4 offset:12288
    v_mfma_f32_16x16x32_bf16 v[156:159], v[56:59], v[92:95], v[156:159]
    ds_read_b64_tr_b16 v[114:115], v4 offset:12800
    v_mfma_f32_16x16x32_bf16 v[160:163], v[72:75], v[60:63], v[160:163]
    ds_read_b64_tr_b16 v[116:117], v5 offset:12288
    v_mfma_f32_16x16x32_bf16 v[164:167], v[76:79], v[60:63], v[164:167]
    ds_read_b64_tr_b16 v[118:119], v5 offset:12800
    v_mfma_f32_16x16x32_bf16 v[168:171], v[80:83], v[60:63], v[168:171]
    ds_read_b64_tr_b16 v[120:121], v4 offset:14336
    v_mfma_f32_16x16x32_bf16 v[172:175], v[84:87], v[60:63], v[172:175]
    ds_read_b64_tr_b16 v[122:123], v4 offset:14848
    v_mfma_f32_16x16x32_bf16 v[176:179], v[60:63], v[88:91], v[176:179]
    ds_read_b64_tr_b16 v[124:125], v5 offset:14336
    v_mfma_f32_16x16x32_bf16 v[180:183], v[60:63], v[92:95], v[180:183]
    ds_read_b64_tr_b16 v[126:127], v5 offset:14848
    v_mfma_f32_16x16x32_bf16 v[184:187], v[72:75], v[64:67], v[184:187]
    ds_read_b64_tr_b16 v[128:129], v4 offset:16384
    v_mfma_f32_16x16x32_bf16 v[188:191], v[76:79], v[64:67], v[188:191]
    ds_read_b64_tr_b16 v[130:131], v4 offset:16896
    v_mfma_f32_16x16x32_bf16 v[192:195], v[80:83], v[64:67], v[192:195]
    ds_read_b64_tr_b16 v[132:133], v5 offset:16384
    v_mfma_f32_16x16x32_bf16 v[196:199], v[84:87], v[64:67], v[196:199]
    ds_read_b64_tr_b16 v[134:135], v5 offset:16896
    v_mfma_f32_16x16x32_bf16 v[200:203], v[64:67], v[88:91], v[200:203]
    v_mfma_f32_16x16x32_bf16 v[204:207], v[64:67], v[92:95], v[204:207]
    v_mfma_f32_16x16x32_bf16 v[208:211], v[72:75], v[68:71], v[208:211]
    v_mfma_f32_16x16x32_bf16 v[212:215], v[76:79], v[68:71], v[212:215]
    v_mfma_f32_16x16x32_bf16 v[216:219], v[80:83], v[68:71], v[216:219]
    v_mfma_f32_16x16x32_bf16 v[220:223], v[84:87], v[68:71], v[220:223]
    v_mfma_f32_16x16x32_bf16 v[224:227], v[68:71], v[88:91], v[224:227]
    v_mfma_f32_16x16x32_bf16 v[228:231], v[68:71], v[92:95], v[228:231]
    s_waitcnt lgkmcnt(0)
    s_barrier
    v_mfma_f32_16x16x32_bf16 v[136:139], v[112:115], v[96:99], v[136:139]
    ds_read_b128 v[56:59], v6 offset:0
    v_mfma_f32_16x16x32_bf16 v[140:143], v[116:119], v[96:99], v[140:143]
    ds_read_b128 v[60:63], v6 offset:2048
    v_mfma_f32_16x16x32_bf16 v[144:147], v[120:123], v[96:99], v[144:147]
    ds_read_b128 v[64:67], v6 offset:4096
    v_mfma_f32_16x16x32_bf16 v[148:151], v[124:127], v[96:99], v[148:151]
    ds_read_b128 v[68:71], v6 offset:6144
    v_mfma_f32_16x16x32_bf16 v[152:155], v[96:99], v[128:131], v[152:155]
    ds_read_b64_tr_b16 v[72:73], v8 offset:0
    v_mfma_f32_16x16x32_bf16 v[156:159], v[96:99], v[132:135], v[156:159]
    ds_read_b64_tr_b16 v[74:75], v8 offset:512
    v_mfma_f32_16x16x32_bf16 v[160:163], v[112:115], v[100:103], v[160:163]
    ds_read_b64_tr_b16 v[76:77], v9 offset:0
    v_mfma_f32_16x16x32_bf16 v[164:167], v[116:119], v[100:103], v[164:167]
    ds_read_b64_tr_b16 v[78:79], v9 offset:512
    v_mfma_f32_16x16x32_bf16 v[168:171], v[120:123], v[100:103], v[168:171]
    ds_read_b64_tr_b16 v[80:81], v8 offset:2048
    v_mfma_f32_16x16x32_bf16 v[172:175], v[124:127], v[100:103], v[172:175]
    ds_read_b64_tr_b16 v[82:83], v8 offset:2560
    v_mfma_f32_16x16x32_bf16 v[176:179], v[100:103], v[128:131], v[176:179]
    ds_read_b64_tr_b16 v[84:85], v9 offset:2048
    v_mfma_f32_16x16x32_bf16 v[180:183], v[100:103], v[132:135], v[180:183]
    ds_read_b64_tr_b16 v[86:87], v9 offset:2560
    v_mfma_f32_16x16x32_bf16 v[184:187], v[112:115], v[104:107], v[184:187]
    ds_read_b64_tr_b16 v[88:89], v8 offset:4096
    v_mfma_f32_16x16x32_bf16 v[188:191], v[116:119], v[104:107], v[188:191]
    ds_read_b64_tr_b16 v[90:91], v8 offset:4608
    v_mfma_f32_16x16x32_bf16 v[192:195], v[120:123], v[104:107], v[192:195]
    ds_read_b64_tr_b16 v[92:93], v9 offset:4096
    v_mfma_f32_16x16x32_bf16 v[196:199], v[124:127], v[104:107], v[196:199]
    ds_read_b64_tr_b16 v[94:95], v9 offset:4608
    v_mfma_f32_16x16x32_bf16 v[200:203], v[104:107], v[128:131], v[200:203]
    s_add_u32 s93, s93, 1
    v_mfma_f32_16x16x32_bf16 v[204:207], v[104:107], v[132:135], v[204:207]
    s_cmp_lt_u32 s93, 5
    v_mfma_f32_16x16x32_bf16 v[208:211], v[112:115], v[108:111], v[208:211]
    v_mfma_f32_16x16x32_bf16 v[212:215], v[116:119], v[108:111], v[212:215]
    v_mfma_f32_16x16x32_bf16 v[216:219], v[120:123], v[108:111], v[216:219]
    v_mfma_f32_16x16x32_bf16 v[220:223], v[124:127], v[108:111], v[220:223]
    v_mfma_f32_16x16x32_bf16 v[224:227], v[108:111], v[128:131], v[224:227]
    v_mfma_f32_16x16x32_bf16 v[228:231], v[108:111], v[132:135], v[228:231]
    s_cbranch_scc1 L_g1loop
    s_waitcnt lgkmcnt(0)
    v_mfma_f32_16x16x32_bf16 v[144:147], v[80:83], v[56:59], v[144:147]
    ds_read_b128 v[96:99], v7 offset:0
    v_mfma_f32_16x16x32_bf16 v[148:151], v[84:87], v[56:59], v[148:151]
    ds_read_b128 v[100:103], v7 offset:2048
    v_mfma_f32_16x16x32_bf16 v[152:155], v[56:59], v[88:91], v[152:155]
    ds_read_b128 v[104:107], v7 offset:4096
    v_mfma_f32_16x16x32_bf16 v[156:159], v[56:59], v[92:95], v[156:159]
    ds_read_b128 v[108:111], v7 offset:6144
    v_mfma_f32_16x16x32_bf16 v[168:171], v[80:83], v[60:63], v[168:171]
    ds_read_b64_tr_b16 v[120:121], v8 offset:14336
    v_mfma_f32_16x16x32_bf16 v[172:175], v[84:87], v[60:63], v[172:175]
    ds_read_b64_tr_b16 v[122:123], v8 offset:14848
    v_mfma_f32_16x16x32_bf16 v[176:179], v[60:63], v[88:91], v[176:179]
    ds_read_b64_tr_b16 v[124:125], v9 offset:14336
    v_mfma_f32_16x16x32_bf16 v[180:183], v[60:63], v[92:95], v[180:183]
    ds_read_b64_tr_b16 v[126:127], v9 offset:14848
    v_mfma_f32_16x16x32_bf16 v[192:195], v[80:83], v[64:67], v[192:195]
    ds_read_b64_tr_b16 v[128:129], v8 offset:16384
    v_mfma_f32_16x16x32_bf16 v[196:199], v[84:87], v[64:67], v[196:199]
    ds_read_b64_tr_b16 v[130:131], v8 offset:16896
    v_mfma_f32_16x16x32_bf16 v[200:203], v[64:67], v[88:91], v[200:203]
    ds_read_b64_tr_b16 v[132:133], v9 offset:16384
    v_mfma_f32_16x16x32_bf16 v[204:207], v[64:67], v[92:95], v[204:207]
    ds_read_b64_tr_b16 v[134:135], v9 offset:16896
    v_mfma_f32_16x16x32_bf16 v[216:219], v[80:83], v[68:71], v[216:219]
    v_mfma_f32_16x16x32_bf16 v[220:223], v[84:87], v[68:71], v[220:223]
    v_mfma_f32_16x16x32_bf16 v[224:227], v[68:71], v[88:91], v[224:227]
    v_mfma_f32_16x16x32_bf16 v[228:231], v[68:71], v[92:95], v[228:231]
    s_waitcnt lgkmcnt(0)
    s_barrier
    v_mfma_f32_16x16x32_bf16 v[144:147], v[120:123], v[96:99], v[144:147]
    ds_read_b128 v[56:59], v10 offset:0
    v_mfma_f32_16x16x32_bf16 v[148:151], v[124:127], v[96:99], v[148:151]
    ds_read_b128 v[60:63], v10 offset:2048
    v_mfma_f32_16x16x32_bf16 v[152:155], v[96:99], v[128:131], v[152:155]
    ds_read_b128 v[64:67], v10 offset:4096
    v_mfma_f32_16x16x32_bf16 v[156:159], v[96:99], v[132:135], v[156:159]
    ds_read_b128 v[68:71], v10 offset:6144
    v_mfma_f32_16x16x32_bf16 v[168:171], v[120:123], v[100:103], v[168:171]
    ds_read_b64_tr_b16 v[80:81], v12 offset:2048
    v_mfma_f32_16x16x32_bf16 v[172:175], v[124:127], v[100:103], v[172:175]
    ds_read_b64_tr_b16 v[82:83], v12 offset:2560
    v_mfma_f32_16x16x32_bf16 v[176:179], v[100:103], v[128:131], v[176:179]
    ds_read_b64_tr_b16 v[84:85], v13 offset:2048
    v_mfma_f32_16x16x32_bf16 v[180:183], v[100:103], v[132:135], v[180:183]
    ds_read_b64_tr_b16 v[86:87], v13 offset:2560
    v_mfma_f32_16x16x32_bf16 v[192:195], v[120:123], v[104:107], v[192:195]
    ds_read_b64_tr_b16 v[88:89], v12 offset:4096
    v_mfma_f32_16x16x32_bf16 v[196:199], v[124:127], v[104:107], v[196:199]
    ds_read_b64_tr_b16 v[90:91], v12 offset:4608
    v_mfma_f32_16x16x32_bf16 v[200:203], v[104:107], v[128:131], v[200:203]
    ds_read_b64_tr_b16 v[92:93], v13 offset:4096
    v_mfma_f32_16x16x32_bf16 v[204:207], v[104:107], v[132:135], v[204:207]
    ds_read_b64_tr_b16 v[94:95], v13 offset:4608
    v_mfma_f32_16x16x32_bf16 v[216:219], v[120:123], v[108:111], v[216:219]
    v_mfma_f32_16x16x32_bf16 v[220:223], v[124:127], v[108:111], v[220:223]
    v_mfma_f32_16x16x32_bf16 v[224:227], v[108:111], v[128:131], v[224:227]
    v_mfma_f32_16x16x32_bf16 v[228:231], v[108:111], v[132:135], v[228:231]
    s_waitcnt lgkmcnt(0)
    v_mfma_f32_16x16x32_bf16 v[144:147], v[80:83], v[56:59], v[144:147]
    ds_read_b128 v[96:99], v11 offset:0
    v_mfma_f32_16x16x32_bf16 v[148:151], v[84:87], v[56:59], v[148:151]
    ds_read_b128 v[100:103], v11 offset:2048
    v_mfma_f32_16x16x32_bf16 v[152:155], v[56:59], v[88:91], v[152:155]
    ds_read_b128 v[104:107], v11 offset:4096
    v_mfma_f32_16x16x32_bf16 v[156:159], v[56:59], v[92:95], v[156:159]
    ds_read_b128 v[108:111], v11 offset:6144
    v_mfma_f32_16x16x32_bf16 v[168:171], v[80:83], v[60:63], v[168:171]
    ds_read_b64_tr_b16 v[120:121], v12 offset:14336
    v_mfma_f32_16x16x32_bf16 v[172:175], v[84:87], v[60:63], v[172:175]
    ds_read_b64_tr_b16 v[122:123], v12 offset:14848
    v_mfma_f32_16x16x32_bf16 v[176:179], v[60:63], v[88:91], v[176:179]
    ds_read_b64_tr_b16 v[124:125], v13 offset:14336
    v_mfma_f32_16x16x32_bf16 v[180:183], v[60:63], v[92:95], v[180:183]
    ds_read_b64_tr_b16 v[126:127], v13 offset:14848
    v_mfma_f32_16x16x32_bf16 v[192:195], v[80:83], v[64:67], v[192:195]
    ds_read_b64_tr_b16 v[128:129], v12 offset:16384
    v_mfma_f32_16x16x32_bf16 v[196:199], v[84:87], v[64:67], v[196:199]
    ds_read_b64_tr_b16 v[130:131], v12 offset:16896
    v_mfma_f32_16x16x32_bf16 v[200:203], v[64:67], v[88:91], v[200:203]
    ds_read_b64_tr_b16 v[132:133], v13 offset:16384
    v_mfma_f32_16x16x32_bf16 v[204:207], v[64:67], v[92:95], v[204:207]
    ds_read_b64_tr_b16 v[134:135], v13 offset:16896
    v_mfma_f32_16x16x32_bf16 v[216:219], v[80:83], v[68:71], v[216:219]
    ds_read_b64_tr_b16 v[112:113], v12 offset:12288
    v_mfma_f32_16x16x32_bf16 v[220:223], v[84:87], v[68:71], v[220:223]
    ds_read_b64_tr_b16 v[114:115], v12 offset:12800
    v_mfma_f32_16x16x32_bf16 v[224:227], v[68:71], v[88:91], v[224:227]
    ds_read_b64_tr_b16 v[116:117], v13 offset:12288
    v_mfma_f32_16x16x32_bf16 v[228:231], v[68:71], v[92:95], v[228:231]
    ds_read_b64_tr_b16 v[118:119], v13 offset:12800
    s_waitcnt lgkmcnt(4)
    v_mfma_f32_16x16x32_bf16 v[144:147], v[120:123], v[96:99], v[144:147]
    ds_read_b128 v[56:59], v6 offset:0
    v_mfma_f32_16x16x32_bf16 v[168:171], v[120:123], v[100:103], v[168:171]
    ds_read_b128 v[60:63], v6 offset:2048
    v_mfma_f32_16x16x32_bf16 v[192:195], v[120:123], v[104:107], v[192:195]
    ds_read_b128 v[64:67], v6 offset:4096
    v_mfma_f32_16x16x32_bf16 v[216:219], v[120:123], v[108:111], v[216:219]
    ds_read_b128 v[68:71], v6 offset:6144
    v_mfma_f32_16x16x32_bf16 v[148:151], v[124:127], v[96:99], v[148:151]
    ds_read_b64_tr_b16 v[72:73], v8 offset:0
    v_mfma_f32_16x16x32_bf16 v[172:175], v[124:127], v[100:103], v[172:175]
    ds_read_b64_tr_b16 v[74:75], v8 offset:512
    v_mfma_f32_16x16x32_bf16 v[196:199], v[124:127], v[104:107], v[196:199]
    ds_read_b64_tr_b16 v[76:77], v9 offset:0
    v_mfma_f32_16x16x32_bf16 v[220:223], v[124:127], v[108:111], v[220:223]
    ds_read_b64_tr_b16 v[78:79], v9 offset:512
    v_mfma_f32_16x16x32_bf16 v[152:155], v[96:99], v[128:131], v[152:155]
    v_mfma_f32_16x16x32_bf16 v[176:179], v[100:103], v[128:131], v[176:179]
    v_mfma_f32_16x16x32_bf16 v[200:203], v[104:107], v[128:131], v[200:203]
    v_mfma_f32_16x16x32_bf16 v[224:227], v[108:111], v[128:131], v[224:227]
    v_mfma_f32_16x16x32_bf16 v[156:159], v[96:99], v[132:135], v[156:159]
    v_mfma_f32_16x16x32_bf16 v[180:183], v[100:103], v[132:135], v[180:183]
    v_mfma_f32_16x16x32_bf16 v[204:207], v[104:107], v[132:135], v[204:207]
    v_mfma_f32_16x16x32_bf16 v[228:231], v[108:111], v[132:135], v[228:231]
    s_waitcnt lgkmcnt(8)
    v_mfma_f32_16x16x32_bf16 v[136:139], v[112:115], v[96:99], v[136:139]
    v_cvt_pk_bf16_f32 v80, v144, v145
    v_cvt_pk_bf16_f32 v81, v146, v147
    v_cvt_pk_bf16_f32 v82, v148, v149
    v_cvt_pk_bf16_f32 v83, v150, v151
    ds_write_b128 v232, v[80:83] offset:0
    v_mfma_f32_16x16x32_bf16 v[140:143], v[116:119], v[96:99], v[140:143]
    v_cvt_pk_bf16_f32 v84, v168, v169
    v_cvt_pk_bf16_f32 v85, v170, v171
    v_cvt_pk_bf16_f32 v86, v172, v173
    v_cvt_pk_bf16_f32 v87, v174, v175
    ds_write_b128 v232, v[84:87] offset:128
    v_mfma_f32_16x16x32_bf16 v[160:163], v[112:115], v[100:103], v[160:163]
    v_cvt_pk_bf16_f32 v88, v192, v193
    v_cvt_pk_bf16_f32 v89, v194, v195
    v_cvt_pk_bf16_f32 v90, v196, v197
    v_cvt_pk_bf16_f32 v91, v198, v199
    ds_write_b128 v232, v[88:91] offset:4096
    v_mfma_f32_16x16x32_bf16 v[164:167], v[116:119], v[100:103], v[164:167]
    v_cvt_pk_bf16_f32 v92, v216, v217
    v_cvt_pk_bf16_f32 v93, v218, v219
    v_cvt_pk_bf16_f32 v94, v220, v221
    v_cvt_pk_bf16_f32 v95, v222, v223
    ds_write_b128 v232, v[92:95] offset:4224
    v_mfma_f32_16x16x32_bf16 v[184:187], v[112:115], v[104:107], v[184:187]
    v_cvt_pk_bf16_f32 v120, v152, v153
    v_cvt_pk_bf16_f32 v121, v154, v155
    v_cvt_pk_bf16_f32 v122, v176, v177
    v_cvt_pk_bf16_f32 v123, v178, v179
    ds_write_b128 v233, v[120:123] offset:2048
    v_mfma_f32_16x16x32_bf16 v[188:191], v[116:119], v[104:107], v[188:191]
    v_cvt_pk_bf16_f32 v124, v156, v157
    v_cvt_pk_bf16_f32 v125, v158, v159
    v_cvt_pk_bf16_f32 v126, v180, v181
    v_cvt_pk_bf16_f32 v127, v182, v183
    ds_write_b128 v233, v[124:127] offset:2304
    v_mfma_f32_16x16x32_bf16 v[208:211], v[112:115], v[108:111], v[208:211]
    v_cvt_pk_bf16_f32 v128, v200, v201
    v_cvt_pk_bf16_f32 v129, v202, v203
    v_cvt_pk_bf16_f32 v130, v224, v225
    v_cvt_pk_bf16_f32 v131, v226, v227
    ds_write_b128 v233, v[128:131] offset:6144
    v_mfma_f32_16x16x32_bf16 v[212:215], v[116:119], v[108:111], v[212:215]
    v_cvt_pk_bf16_f32 v132, v204, v205
    v_cvt_pk_bf16_f32 v133, v206, v207
    v_cvt_pk_bf16_f32 v134, v228, v229
    v_cvt_pk_bf16_f32 v135, v230, v231
    ds_write_b128 v233, v[132:135] offset:6400
    ds_read_b128 v[96:99], v7 offset:0
    ds_read_b128 v[100:103], v7 offset:2048
    ds_read_b128 v[104:107], v7 offset:4096
    ds_read_b128 v[108:111], v7 offset:6144
    ds_read_b64_tr_b16 v[112:113], v8 offset:12288
    ds_read_b64_tr_b16 v[114:115], v8 offset:12800
    ds_read_b64_tr_b16 v[116:117], v9 offset:12288
    ds_read_b64_tr_b16 v[118:119], v9 offset:12800
    s_waitcnt lgkmcnt(8)
    s_barrier
    v_mfma_f32_16x16x32_bf16 v[136:139], v[72:75], v[56:59], v[136:139]
    v_mfma_f32_16x16x32_bf16 v[140:143], v[76:79], v[56:59], v[140:143]
    v_mfma_f32_16x16x32_bf16 v[160:163], v[72:75], v[60:63], v[160:163]
    v_mfma_f32_16x16x32_bf16 v[164:167], v[76:79], v[60:63], v[164:167]
    v_mfma_f32_16x16x32_bf16 v[184:187], v[72:75], v[64:67], v[184:187]
    v_mfma_f32_16x16x32_bf16 v[188:191], v[76:79], v[64:67], v[188:191]
    v_mfma_f32_16x16x32_bf16 v[208:211], v[72:75], v[68:71], v[208:211]
    v_mfma_f32_16x16x32_bf16 v[212:215], v[76:79], v[68:71], v[212:215]
    ds_read_b128 v[56:59], v10 offset:0
    ds_read_b128 v[60:63], v10 offset:2048
    ds_read_b128 v[64:67], v10 offset:4096
    ds_read_b128 v[68:71], v10 offset:6144
    ds_read_b64_tr_b16 v[72:73], v12 offset:0
    ds_read_b64_tr_b16 v[74:75], v12 offset:512
    ds_read_b64_tr_b16 v[76:77], v13 offset:0
    ds_read_b64_tr_b16 v[78:79], v13 offset:512
    s_waitcnt lgkmcnt(8)
    v_mfma_f32_16x16x32_bf16 v[136:139], v[112:115], v[96:99], v[136:139]
    v_mfma_f32_16x16x32_bf16 v[140:143], v[116:119], v[96:99], v[140:143]
    v_mfma_f32_16x16x32_bf16 v[160:163], v[112:115], v[100:103], v[160:163]
    v_mfma_f32_16x16x32_bf16 v[164:167], v[116:119], v[100:103], v[164:167]
    v_mfma_f32_16x16x32_bf16 v[184:187], v[112:115], v[104:107], v[184:187]
    v_mfma_f32_16x16x32_bf16 v[188:191], v[116:119], v[104:107], v[188:191]
    v_mfma_f32_16x16x32_bf16 v[208:211], v[112:115], v[108:111], v[208:211]
    v_mfma_f32_16x16x32_bf16 v[212:215], v[116:119], v[108:111], v[212:215]
    s_lshl_b32 s90, s84, 2
    s_add_u32 s90, s90, s85
    s_lshl_b32 s91, s90, 11
    s_add_u32 s91, s91, 122880
    v_add_u32 v2, s91, v1
    s_lshl_b32 s91, s90, 12
    v_add_u32 v3, s91, v1
    s_lshl_b32 s91, s84, 14
    v_add_u32 v6, s91, v1
    s_waitcnt lgkmcnt(0)
    v_mfma_f32_16x16x32_bf16 v[136:139], v[72:75], v[56:59], v[136:139]
    v_mfma_f32_16x16x32_bf16 v[140:143], v[76:79], v[56:59], v[140:143]
    v_mfma_f32_16x16x32_bf16 v[160:163], v[72:75], v[60:63], v[160:163]
    v_mfma_f32_16x16x32_bf16 v[164:167], v[76:79], v[60:63], v[164:167]
    v_mfma_f32_16x16x32_bf16 v[184:187], v[72:75], v[64:67], v[184:187]
    v_mfma_f32_16x16x32_bf16 v[188:191], v[76:79], v[64:67], v[188:191]
    v_mfma_f32_16x16x32_bf16 v[208:211], v[72:75], v[68:71], v[208:211]
    v_mfma_f32_16x16x32_bf16 v[212:215], v[76:79], v[68:71], v[212:215]
    ds_read_b128 v[56:59], v3 offset:0
    ds_read_b128 v[60:63], v3 offset:1024
    ds_read_b128 v[72:75], v6 offset:0
    ds_read_b128 v[76:79], v6 offset:1024
    ds_read_b128 v[88:91], v6 offset:4096
    ds_read_b128 v[92:95], v6 offset:5120
    ds_read_b128 v[104:107], v6 offset:8192
    ds_read_b128 v[108:111], v6 offset:9216
    ds_read_b128 v[64:67], v3 offset:2048
    ds_read_b128 v[68:71], v3 offset:3072
    ds_read_b128 v[80:83], v6 offset:2048
    ds_read_b128 v[84:87], v6 offset:3072
    ds_read_b128 v[96:99], v6 offset:6144
    ds_read_b128 v[100:103], v6 offset:7168
    ds_read_b128 v[112:115], v6 offset:10240
    ds_read_b128 v[116:119], v6 offset:11264
    v_mul_f32 v136, s88, v136
    v_mul_f32 v137, s88, v137
    v_mul_f32 v138, s88, v138
    v_mul_f32 v139, s88, v139
    v_mul_f32 v140, s88, v140
    v_mul_f32 v141, s88, v141
    v_mul_f32 v142, s88, v142
    v_mul_f32 v143, s88, v143
    v_cvt_pk_bf16_f32 v16, v136, v137
    v_cvt_pk_bf16_f32 v17, v138, v139
    v_cvt_pk_bf16_f32 v18, v140, v141
    v_cvt_pk_bf16_f32 v19, v142, v143
    ds_write_b128 v234, v[16:19] offset:0
    v_mul_f32 v160, s88, v160
    v_mul_f32 v161, s88, v161
    v_mul_f32 v162, s88, v162
    v_mul_f32 v163, s88, v163
    v_mul_f32 v164, s88, v164
    v_mul_f32 v165, s88, v165
    v_mul_f32 v166, s88, v166
    v_mul_f32 v167, s88, v167
    v_cvt_pk_bf16_f32 v20, v160, v161
    v_cvt_pk_bf16_f32 v21, v162, v163
    v_cvt_pk_bf16_f32 v22, v164, v165
    v_cvt_pk_bf16_f32 v23, v166, v167
    ds_write_b128 v234, v[20:23] offset:256
    v_mul_f32 v184, s88, v184
    v_mul_f32 v185, s88, v185
    v_mul_f32 v186, s88, v186
    v_mul_f32 v187, s88, v187
    v_mul_f32 v188, s88, v188
    v_mul_f32 v189, s88, v189
    v_mul_f32 v190, s88, v190
    v_mul_f32 v191, s88, v191
    v_cvt_pk_bf16_f32 v24, v184, v185
    v_cvt_pk_bf16_f32 v25, v186, v187
    v_cvt_pk_bf16_f32 v26, v188, v189
    v_cvt_pk_bf16_f32 v27, v190, v191
    ds_write_b128 v234, v[24:27] offset:2048
    v_mul_f32 v208, s88, v208
    v_mul_f32 v209, s88, v209
    v_mul_f32 v210, s88, v210
    v_mul_f32 v211, s88, v211
    v_mul_f32 v212, s88, v212
    v_mul_f32 v213, s88, v213
    v_mul_f32 v214, s88, v214
    v_mul_f32 v215, s88, v215
    v_cvt_pk_bf16_f32 v28, v208, v209
    v_cvt_pk_bf16_f32 v29, v210, v211
    v_cvt_pk_bf16_f32 v30, v212, v213
    v_cvt_pk_bf16_f32 v31, v214, v215
    ds_write_b128 v234, v[28:31] offset:2304
    s_waitcnt lgkmcnt(0)
    s_barrier
    s_load_dword s89, s[70:71], 0
    ds_read_b128 v[16:19], v2
    ds_read_b128 v[20:23], v2 offset:1024
    s_waitcnt lgkmcnt(0)
    s_mul_i32 s89, s89, 0x9e3779b1
    s_add_u32 s89, s89, 0x7f4a7c15
    s_getreg_b32 s64, hwreg(HW_REG_XCC_ID, 0, 4)
    s_add_u32 s64, s64, s89
    s_add_u32 s95, s85, 1
    v_mfma_f32_32x32x16_bf16 v[120:135], v[56:59], v[16:19], v[40:55]
    v_mfma_f32_32x32x16_bf16 v[120:135], v[60:63], v[20:23], v[120:135]
    v_mfma_f32_32x32x16_bf16 v[136:151], v[72:75], v[16:19], 0
    v_mfma_f32_32x32x16_bf16 v[136:151], v[76:79], v[20:23], v[136:151]
    v_mfma_f32_32x32x16_bf16 v[152:167], v[88:91], v[16:19], 0
    s_nop 8
    v_max_f32 v4, v120, v121
    v_max_f32 v5, v122, v123
    v_max3_f32 v4, v4, v124, v125
    v_max3_f32 v5, v5, v126, v127
    v_mfma_f32_32x32x16_bf16 v[152:167], v[92:95], v[20:23], v[152:167]
    v_max3_f32 v4, v4, v128, v129
    v_max3_f32 v5, v5, v130, v131
    v_max3_f32 v4, v4, v132, v133
    v_max3_f32 v5, v5, v134, v135
    s_cmp_gt_u32 s95, 3
    s_cbranch_scc0 Lh_26
    v_mfma_f32_32x32x16_bf16 v[120:135], v[104:107], v[16:19], 0
    v_max3_f32 v4, v4, v136, v137
    v_max3_f32 v5, v5, v138, v139
    v_max3_f32 v4, v4, v140, v141
    v_max3_f32 v5, v5, v142, v143
    v_mfma_f32_32x32x16_bf16 v[120:135], v[108:111], v[20:23], v[120:135]
    v_max3_f32 v4, v4, v144, v145
    v_max3_f32 v5, v5, v146, v147
    v_max3_f32 v4, v4, v148, v149
    v_max3_f32 v5, v5, v150, v151
    v_max3_f32 v4, v4, v152, v153
    v_max3_f32 v5, v5, v154, v155
    v_max3_f32 v4, v4, v156, v157
    v_max3_f32 v5, v5, v158, v159
    v_max3_f32 v4, v4, v160, v161
    v_max3_f32 v5, v5, v162, v163
    v_max3_f32 v4, v4, v164, v165
    v_max3_f32 v5, v5, v166, v167
    v_max3_f32 v4, v4, v120, v121
    v_max3_f32 v5, v5, v122, v123
    v_max3_f32 v4, v4, v124, v125
    v_max3_f32 v5, v5, v126, v127
    v_max3_f32 v4, v4, v128, v129
    v_max3_f32 v5, v5, v130, v131
    v_max3_f32 v4, v4, v132, v133
    v_max3_f32 v5, v5, v134, v135
    s_branch Lh_27
Lh_26:
    v_max3_f32 v4, v4, v136, v137
    v_max3_f32 v5, v5, v138, v139
    v_max3_f32 v4, v4, v140, v141
    v_max3_f32 v5, v5, v142, v143
    v_max3_f32 v4, v4, v144, v145
    v_max3_f32 v5, v5, v146, v147
    v_max3_f32 v4, v4, v148, v149
    v_max3_f32 v5, v5, v150, v151
    v_max3_f32 v4, v4, v152, v153
    v_max3_f32 v5, v5, v154, v155
    v_max3_f32 v4, v4, v156, v157
    v_max3_f32 v5, v5, v158, v159
    v_max3_f32 v4, v4, v160, v161
    v_max3_f32 v5, v5, v162, v163
    v_max3_f32 v4, v4, v164, v165
    v_max3_f32 v5, v5, v166, v167
Lh_27:
    v_max_f32 v4, v4, v5
    v_mov_b32 v5, v4
    s_nop 1
    v_permlane32_swap_b32 v4, v5
    v_max_f32 v4, v4, v5
    v_sub_f32 v120, v40, v4
    v_sub_f32 v121, v41, v4
    v_sub_f32 v122, v42, v4
    v_sub_f32 v123, v43, v4
    v_sub_f32 v124, v44, v4
    v_sub_f32 v125, v45, v4
    v_sub_f32 v126, v46, v4
    v_sub_f32 v127, v47, v4
    v_sub_f32 v128, v48, v4
    v_sub_f32 v129, v49, v4
    v_sub_f32 v130, v50, v4
    v_sub_f32 v131, v51, v4
    v_sub_f32 v132, v52, v4
    v_sub_f32 v133, v53, v4
    v_sub_f32 v134, v54, v4
    v_sub_f32 v135, v55, v4
    v_mov_b32 v12, v4
    v_sub_f32 v168, 0, v4
    v_mfma_f32_32x32x16_bf16 v[120:135], v[56:59], v[16:19], v[120:135]
    v_mov_b32 v169, v168
    v_mov_b32 v170, v168
    v_mov_b32 v171, v168
    v_mov_b32 v172, v168
    v_mov_b32 v173, v168
    v_mfma_f32_32x32x16_bf16 v[120:135], v[60:63], v[20:23], v[120:135]
    v_mov_b32 v174, v168
    v_mov_b32 v175, v168
    v_mov_b32 v176, v168
    v_mov_b32 v177, v168
    v_mov_b32 v178, v168
    v_mov_b32 v179, v168
    v_mov_b32 v180, v168
    v_mov_b32 v181, v168
    v_mov_b32 v182, v168
    v_mov_b32 v183, v168
    s_nop 1
    v_exp_f32 v120, v120
    v_exp_f32 v121, v121
    v_exp_f32 v122, v122
    v_exp_f32 v123, v123
    v_exp_f32 v124, v124
    v_mfma_f32_32x32x16_bf16 v[136:151], v[72:75], v[16:19], v[168:183]
    v_exp_f32 v125, v125
    v_exp_f32 v126, v126
    v_exp_f32 v127, v127
    v_cvt_pk_bf16_f32 v120, v120, v121
    v_cvt_pk_bf16_f32 v121, v122, v123
    v_cvt_pk_bf16_f32 v122, v124, v125
    v_cvt_pk_bf16_f32 v123, v126, v127
    v_mfma_f32_32x32x16_bf16 v[136:151], v[76:79], v[20:23], v[136:151]
    v_exp_f32 v128, v128
    v_exp_f32 v129, v129
    v_exp_f32 v130, v130
    v_mfma_f32_32x32x16_bf16 v[24:39], v[64:67], v[120:123], 0
    v_exp_f32 v131, v131
    v_exp_f32 v132, v132
    v_exp_f32 v133, v133
    v_mfma_f32_16x16x32_bf16 v[8:11], v[236:239], v[120:123], 0
    v_exp_f32 v134, v134
    v_exp_f32 v135, v135
    v_cvt_pk_bf16_f32 v128, v128, v129
    v_cvt_pk_bf16_f32 v129, v130, v131
    v_cvt_pk_bf16_f32 v130, v132, v133
    v_cvt_pk_bf16_f32 v131, v134, v135
    v_exp_f32 v136, v136
    v_exp_f32 v137, v137
    v_mfma_f32_32x32x16_bf16 v[24:39], v[68:71], v[128:131], v[24:39]
    v_exp_f32 v138, v138
    v_exp_f32 v139, v139
    v_exp_f32 v140, v140
    v_mfma_f32_32x32x16_bf16 v[152:167], v[88:91], v[16:19], v[168:183]
    v_exp_f32 v141, v141
    v_exp_f32 v142, v142
    v_mfma_f32_16x16x32_bf16 v[8:11], v[236:239], v[128:131], v[8:11]
    v_exp_f32 v143, v143
    v_cvt_pk_bf16_f32 v136, v136, v137
    v_cvt_pk_bf16_f32 v137, v138, v139
    v_cvt_pk_bf16_f32 v138, v140, v141
    v_cvt_pk_bf16_f32 v139, v142, v143
    v_mfma_f32_32x32x16_bf16 v[152:167], v[92:95], v[20:23], v[152:167]
    v_exp_f32 v144, v144
    v_exp_f32 v145, v145
    v_exp_f32 v146, v146
    v_mfma_f32_32x32x16_bf16 v[24:39], v[80:83], v[136:139], v[24:39]
    v_exp_f32 v147, v147
    v_exp_f32 v148, v148
    v_exp_f32 v149, v149
    v_mfma_f32_16x16x32_bf16 v[8:11], v[236:239], v[136:139], v[8:11]
    v_exp_f32 v150, v150
    v_exp_f32 v151, v151
    v_cvt_pk_bf16_f32 v144, v144, v145
    v_cvt_pk_bf16_f32 v145, v146, v147
    v_cvt_pk_bf16_f32 v146, v148, v149
    v_cvt_pk_bf16_f32 v147, v150, v151
    v_exp_f32 v152, v152
    v_exp_f32 v153, v153
    v_mfma_f32_32x32x16_bf16 v[24:39], v[84:87], v[144:147], v[24:39]
    v_exp_f32 v154, v154
    v_exp_f32 v155, v155
    v_exp_f32 v156, v156
    v_mfma_f32_32x32x16_bf16 v[120:135], v[104:107], v[16:19], v[168:183]
    v_exp_f32 v157, v157
    v_exp_f32 v158, v158
    v_mfma_f32_16x16x32_bf16 v[8:11], v[236:239], v[144:147], v[8:11]
    v_exp_f32 v159, v159
    v_cvt_pk_bf16_f32 v152, v152, v153
    v_cvt_pk_bf16_f32 v153, v154, v155
    v_cvt_pk_bf16_f32 v154, v156, v157
    v_cvt_pk_bf16_f32 v155, v158, v159
    v_mfma_f32_32x32x16_bf16 v[120:135], v[108:111], v[20:23], v[120:135]
    v_exp_f32 v160, v160
    v_exp_f32 v161, v161
    v_exp_f32 v162, v162
    v_mfma_f32_32x32x16_bf16 v[24:39], v[96:99], v[152:155], v[24:39]
    v_exp_f32 v163, v163
    v_exp_f32 v164, v164
    v_exp_f32 v165, v165
    v_mfma_f32_16x16x32_bf16 v[8:11], v[236:239], v[152:155], v[8:11]
    v_exp_f32 v166, v166
    v_exp_f32 v167, v167
    v_cvt_pk_bf16_f32 v160, v160, v161
    v_cvt_pk_bf16_f32 v161, v162, v163
    v_cvt_pk_bf16_f32 v162, v164, v165
    v_cvt_pk_bf16_f32 v163, v166, v167
    s_cmp_gt_u32 s95, 3
    s_cbranch_scc0 Lh_28
    v_exp_f32 v120, v120
    v_exp_f32 v121, v121
    v_mfma_f32_32x32x16_bf16 v[24:39], v[100:103], v[160:163], v[24:39]
    v_exp_f32 v122, v122
    v_exp_f32 v123, v123
    v_exp_f32 v124, v124
    v_exp_f32 v125, v125
    v_exp_f32 v126, v126
    v_mfma_f32_16x16x32_bf16 v[8:11], v[236:239], v[160:163], v[8:11]
    v_exp_f32 v127, v127
    v_cvt_pk_bf16_f32 v120, v120, v121
    v_cvt_pk_bf16_f32 v121, v122, v123
    v_cvt_pk_bf16_f32 v122, v124, v125
    v_cvt_pk_bf16_f32 v123, v126, v127
    v_exp_f32 v128, v128
    v_exp_f32 v129, v129
    v_exp_f32 v130, v130
    v_mfma_f32_32x32x16_bf16 v[24:39], v[112:115], v[120:123], v[24:39]
    v_exp_f32 v131, v131
    v_exp_f32 v132, v132
    v_exp_f32 v133, v133
    v_mfma_f32_16x16x32_bf16 v[8:11], v[236:239], v[120:123], v[8:11]
    v_exp_f32 v134, v134
    v_exp_f32 v135, v135
    v_cvt_pk_bf16_f32 v128, v128, v129
    v_cvt_pk_bf16_f32 v129, v130, v131
    v_cvt_pk_bf16_f32 v130, v132, v133
    v_cvt_pk_bf16_f32 v131, v134, v135
    s_nop 1
    v_mfma_f32_32x32x16_bf16 v[24:39], v[116:119], v[128:131], v[24:39]
    v_mfma_f32_16x16x32_bf16 v[8:11], v[236:239], v[128:131], v[8:11]
    s_branch Lh_29
Lh_28:
    v_mfma_f32_32x32x16_bf16 v[24:39], v[100:103], v[160:163], v[24:39]
    v_mfma_f32_16x16x32_bf16 v[8:11], v[236:239], v[160:163], v[8:11]
Lh_29:
    s_cmp_eq_u32 s82, 1
    s_cselect_b32 s90, 4, s85
    s_cselect_b32 s92, 0, -1
    s_sub_u32 s95, 8, s90
    s_lshl_b32 s91, s84, 14
    v_add_u32 v3, s91, v1
    s_lshl_b32 s90, s90, 11
    v_add_u32 v2, s90, v3
    s_and_b32 s92, s92, 0xff800000
    v_bfi_b32 v40, v40, 0, s92
    v_bfi_b32 v41, v41, 0, s92
    v_bfi_b32 v42, v42, 0, s92
    v_bfi_b32 v43, v43, 0, s92
    v_bfi_b32 v44, v44, 0, s92
    v_bfi_b32 v45, v45, 0, s92
    v_bfi_b32 v46, v46, 0, s92
    v_bfi_b32 v47, v47, 0, s92
    v_bfi_b32 v48, v48, 0, s92
    v_bfi_b32 v49, v49, 0, s92
    v_bfi_b32 v50, v50, 0, s92
    v_bfi_b32 v51, v51, 0, s92
    v_bfi_b32 v52, v52, 0, s92
    v_bfi_b32 v53, v53, 0, s92
    v_bfi_b32 v54, v54, 0, s92
    v_bfi_b32 v55, v55, 0, s92
    v_lshrrev_b32 v14, 3, v0
    v_lshrrev_b32 v15, 4, v0
    v_lshlrev_b32 v15, 1, v15
    v_and_b32 v248, 7, v0
    v_xor_b32 v15, v15, v248
    v_lshlrev_b32 v15, 4, v15
    v_lshl_add_u32 v14, v14, 11, v15
    s_lshl_b32 s90, s78, 7
    v_add_u32 v14, s90, v14
    v_add_u32 v15, 15360, v14
    v_and_b32 v6, 16, v0
    v_lshlrev_b32 v6, 11, v6
    v_and_b32 v7, 15, v0
    v_lshl_add_u32 v6, v7, 4, v6
    v_and_b32 v7, 32, v0
    v_lshl_add_u32 v6, v7, 3, v6
    s_add_u32 s90, s87, s85
    s_lshl_b32 s91, s90, 16
    s_lshl_b32 s92, s86, 10
    s_add_u32 s91, s91, s92
    s_add_u32 s91, s91, 0x800000
    v_add_u32 v6, s91, v6
    s_lshl_b32 s75, s80, 4
    s_lshr_b32 s91, s81, 1
    s_add_u32 s75, s75, s91
    s_and_b32 s92, s81, 1
    s_and_b32 s90, s75, 15
    s_lshl_b32 s90, s90, 4
    s_add_u32 s74, s90, s80
    s_add_u32 s91, s90, 8
    s_sub_u32 s90, s90, 128
    s_cmp_lt_u32 s75, 8
    s_cselect_b32 s90, s91, s90
    s_cmp_eq_u32 s80, 0
    s_cselect_b32 s74, s90, s74
    s_lshl_b32 s90, s92, 2
    s_add_u32 s90, s90, s3
    s_mov_b32 s76, 0
    s_cmp_eq_u32 s75, 8
    s_cbranch_scc0 Lb2g_30
    s_mov_b32 s90, s3
    s_sub_u32 s76, 2, s92
    s_cmp_eq_u32 s92, 0
    s_cselect_b32 s74, 128, 0
Lb2g_30:
    s_lshl_b32 s90, s90, 8
    s_add_u32 s74, s74, s90
    v_cvt_f32_u32 v120, s74
    v_mul_f32 v120, 0x3a000000, v120
    v_and_b32 v121, 1, v0
    v_cvt_f32_u32 v121, v121
    v_mul_f32 v121, 0x3e800000, v121
    v_cos_f32 v122, v121
    v_sin_f32 v130, v121
    v_add_f32 v121, v121, v120
    v_cos_f32 v123, v121
    v_sin_f32 v131, v121
    v_add_f32 v121, v121, v120
    v_cos_f32 v124, v121
    v_sin_f32 v132, v121
    v_add_f32 v121, v121, v120
    v_cos_f32 v125, v121
    v_sin_f32 v133, v121
    v_add_f32 v121, v121, v120
    v_cos_f32 v126, v121
    v_sin_f32 v134, v121
    v_add_f32 v121, v121, v120
    v_cos_f32 v127, v121
    v_sin_f32 v135, v121
    v_add_f32 v121, v121, v120
    v_cos_f32 v128, v121
    v_sin_f32 v136, v121
    v_add_f32 v121, v121, v120
    v_cos_f32 v129, v121
    v_sin_f32 v137, v121
    s_mov_b32 s90, 0x300003
    s_mov_b32 s91, 0x30000300
    s_cmp_eq_u32 s76, 2
    s_cselect_b64 vcc, -1, 0
    v_cvt_pk_bf16_f32 v122, v122, v123
    v_cvt_pk_bf16_f32 v130, v130, v131
    v_cndmask_b32 v130, v130, v122, vcc
    v_cvt_pk_bf16_f32 v123, v124, v125
    v_cvt_pk_bf16_f32 v131, v132, v133
    v_cndmask_b32 v131, v131, v123, vcc
    v_cvt_pk_bf16_f32 v124, v126, v127
    v_cvt_pk_bf16_f32 v132, v134, v135
    v_cndmask_b32 v132, v132, v124, vcc
    v_cvt_pk_bf16_f32 v125, v128, v129
    v_cvt_pk_bf16_f32 v133, v136, v137
    v_cndmask_b32 v133, v133, v125, vcc
    s_cselect_b64 vcc, 0, s[90:91]
    v_cndmask_b32 v200, 0, v122, vcc
    v_cndmask_b32 v201, 0, v123, vcc
    v_cndmask_b32 v202, 0, v124, vcc
    v_cndmask_b32 v203, 0, v125, vcc
    s_cmp_eq_u32 s76, 1
    s_cselect_b64 vcc, 0, s[90:91]
    v_cndmask_b32 v204, 0, v130, vcc
    v_cndmask_b32 v205, 0, v131, vcc
    v_cndmask_b32 v206, 0, v132, vcc
    v_cndmask_b32 v207, 0, v133, vcc
    v_and_b32 v120, 48, v0
    v_add_u32 v120, 155648, v120
    v_and_b32 v121, 12, v0
    v_and_b32 v122, 3, v0
    v_lshl_add_u32 v121, v121, 1, v122
    v_lshl_add_u32 v208, v121, 6, v120
    v_and_b32 v121, 15, v0
    v_lshl_add_u32 v209, v121, 6, v120
    v_and_b32 v120, 32, v0
    v_lshlrev_b32 v120, 2, v120
    v_xor_b32 v210, v120, v1
    v_xor_b32 v212, 0, v210
    v_xor_b32 v213, 32, v210
    v_xor_b32 v214, 64, v210
    v_xor_b32 v215, 96, v210
    s_lshl_b32 s90, s3, 13
    v_add_u32 v216, s90, v1
    v_lshrrev_b32 v120, 2, v0
    v_and_b32 v120, 7, v120
    v_lshlrev_b32 v122, 3, v122
    v_lshl_add_u32 v122, v120, 5, v122
    v_and_b32 v120, 12, v0
    v_lshl_add_u32 v122, v120, 8, v122
    v_and_b32 v120, 16, v0
    v_lshl_add_u32 v122, v120, 5, v122
    v_and_b32 v120, 32, v0
    v_lshl_add_u32 v211, v120, 8, v122
    v_and_b32 v252, 48, v0
    v_lshl_add_u32 v252, v252, 1, v121
    s_lshr_b32 s90, s80, 1
    s_lshl_b32 s90, s90, 8
    s_and_b32 s91, s3, 2
    s_lshl_b32 s91, s91, 6
    s_add_u32 s90, s90, s91
    s_and_b32 s91, s3, 1
    s_lshl_b32 s91, s91, 4
    s_add_u32 s90, s90, s91
    v_add_u32 v252, s90, v252
    v_lshlrev_b32 v252, 7, v252
    v_add_u32 v252, 0x1060000, v252
    s_lshl_b32 s90, s75, 15
    s_and_b32 s91, s3, 2
    s_lshl_b32 s91, s91, 13
    s_add_u32 s90, s90, s91
    s_and_b32 s91, s3, 1
    s_lshl_b32 s91, s91, 10
    s_add_u32 s90, s90, s91
    s_add_u32 s66, s90, 0xc00000
    s_lshl_b32 s67, s3, 13
    s_barrier
    s_barrier
    s_setprio 2
L_att:
    ds_read_b128 v[56:59], v2 offset:32768
    ds_read_b128 v[60:63], v2 offset:33792
    ds_read_b128 v[64:67], v3 offset:47104
    ds_read_b128 v[68:71], v3 offset:48128
    ds_read_b128 v[72:75], v3 offset:45056
    ds_read_b128 v[76:79], v3 offset:46080
    ds_read_b128 v[80:83], v3 offset:43008
    ds_read_b128 v[84:87], v3 offset:44032
    ds_read_b128 v[88:91], v3 offset:40960
    ds_read_b128 v[92:95], v3 offset:41984
    ds_read_b128 v[96:99], v3 offset:38912
    ds_read_b128 v[100:103], v3 offset:39936
    ds_read_b128 v[104:107], v3 offset:36864
    ds_read_b128 v[108:111], v3 offset:37888
    ds_read_b128 v[112:115], v3 offset:34816
    ds_read_b128 v[116:119], v3 offset:35840
    s_cmp_lt_u32 s3, 4
    s_cbranch_scc1 Ls_31
    s_mul_i32 s72, s94, 22
    s_add_u32 s72, s72, 32
    s_lshl_b32 s73, s72, 10
    s_add_u32 m0, s73, 32768
    s_lshl_b32 s72, s72, 14
    buffer_load_dwordx4 v14, s[36:39], s72 offen lds
    buffer_load_dwordx4 v15, s[36:39], s72 offen offset:1024 lds
    s_add_u32 m0, m0, 2048
    s_add_u32 s72, s72, 32768
    buffer_load_dwordx4 v14, s[36:39], s72 offen lds
    buffer_load_dwordx4 v15, s[36:39], s72 offen offset:1024 lds
    s_add_u32 m0, m0, 2048
    s_add_u32 s72, s72, 32768
    buffer_load_dwordx4 v14, s[36:39], s72 offen lds
    buffer_load_dwordx4 v15, s[36:39], s72 offen offset:1024 lds
    s_add_u32 m0, m0, 2048
    s_add_u32 s72, s72, 32768
    buffer_load_dwordx4 v14, s[36:39], s72 offen lds
    buffer_load_dwordx4 v15, s[36:39], s72 offen offset:1024 lds
    s_add_u32 m0, m0, 2048
    s_add_u32 s72, s72, 32768
    s_waitcnt vmcnt(8) lgkmcnt(0)
    s_barrier
    s_sub_u32 s90, s3, 4
    s_lshl_b32 s90, s90, 3
    s_add_u32 s90, s90, s80
    s_lshl_b32 s90, s90, 5
    s_add_u32 s90, s90, s18
    s_lshl_b32 s90, s90, 7
    s_add_u32 s90, s90, 0x1060000
    v_lshl_add_u32 v250, v0, 2, s90
    v_mov_b32 v251, s89
    s_mov_b32 exec_hi, 0
    buffer_store_dword v251, v250, s[56:59], 0 offen sc1
    s_mov_b32 exec_hi, -1
    buffer_load_dwordx4 v14, s[36:39], s72 offen lds
    buffer_load_dwordx4 v15, s[36:39], s72 offen offset:1024 lds
    s_add_u32 m0, m0, 2048
    s_add_u32 s72, s72, 32768
    buffer_load_dwordx4 v14, s[36:39], s72 offen lds
    buffer_load_dwordx4 v15, s[36:39], s72 offen offset:1024 lds
    s_add_u32 m0, m0, 2048
    s_add_u32 s72, s72, 32768
    buffer_load_dwordx4 v14, s[36:39], s72 offen lds
    buffer_load_dwordx4 v15, s[36:39], s72 offen offset:1024 lds
    s_add_u32 m0, m0, 2048
    s_add_u32 s72, s72, 32768
    buffer_load_dwordx4 v14, s[36:39], s72 offen lds
    buffer_load_dwordx4 v15, s[36:39], s72 offen offset:1024 lds
    s_add_u32 m0, m0, 2048
    s_add_u32 s72, s72, 32768
    buffer_load_dwordx4 v14, s[36:39], s72 offen lds
    buffer_load_dwordx4 v15, s[36:39], s72 offen offset:1024 lds
    s_add_u32 m0, m0, 2048
    s_add_u32 s72, s72, 32768
    buffer_load_dwordx4 v14, s[36:39], s72 offen lds
    buffer_load_dwordx4 v15, s[36:39], s72 offen offset:1024 lds
    s_add_u32 m0, m0, 2048
    s_add_u32 s72, s72, 32768
    buffer_load_dwordx4 v14, s[36:39], s72 offen lds
    buffer_load_dwordx4 v15, s[36:39], s72 offen offset:1024 lds
    s_add_u32 m0, m0, 2048
    s_add_u32 s72, s72, 32768
    s_mul_i32 s72, s94, 8
    s_add_u32 s72, s72, 0
    s_lshl_b32 s73, s72, 10
    s_add_u32 m0, s73, 32768
    s_lshl_b32 s72, s72, 14
    buffer_load_dwordx4 v14, s[36:39], s72 offen lds
    buffer_load_dwordx4 v15, s[36:39], s72 offen offset:1024 lds
    s_add_u32 m0, m0, 2048
    s_add_u32 s72, s72, 32768
    buffer_load_dwordx4 v14, s[36:39], s72 offen lds
    buffer_load_dwordx4 v15, s[36:39], s72 offen offset:1024 lds
    s_add_u32 m0, m0, 2048
    s_add_u32 s72, s72, 32768
    buffer_load_dwordx4 v14, s[36:39], s72 offen lds
    buffer_load_dwordx4 v15, s[36:39], s72 offen offset:1024 lds
    s_add_u32 m0, m0, 2048
    s_add_u32 s72, s72, 32768
    buffer_load_dwordx4 v14, s[36:39], s72 offen lds
    buffer_load_dwordx4 v15, s[36:39], s72 offen offset:1024 lds
    s_add_u32 m0, m0, 2048
    s_add_u32 s72, s72, 32768
Ls_31:
    s_cmp_eq_u32 s82, 0
    s_cbranch_scc1 Lno_34
    s_waitcnt lgkmcnt(14)
    v_mfma_f32_32x32x16_bf16 v[120:135], v[56:59], v[16:19], v[40:55]
    v_mfma_f32_32x32x16_bf16 v[120:135], v[60:63], v[20:23], v[120:135]
    s_waitcnt lgkmcnt(12)
    v_mfma_f32_32x32x16_bf16 v[136:151], v[64:67], v[16:19], 0
    v_mfma_f32_32x32x16_bf16 v[136:151], v[68:71], v[20:23], v[136:151]
    s_waitcnt lgkmcnt(10)
    v_mfma_f32_32x32x16_bf16 v[152:167], v[72:75], v[16:19], 0
    s_nop 6
    v_max3_f32 v4, v12, v120, v121
    v_max_f32 v5, v122, v123
    v_max3_f32 v4, v4, v124, v125
    v_max3_f32 v5, v5, v126, v127
    v_mfma_f32_32x32x16_bf16 v[152:167], v[76:79], v[20:23], v[152:167]
    v_max3_f32 v4, v4, v128, v129
    v_max3_f32 v5, v5, v130, v131
    v_max3_f32 v4, v4, v132, v133
    v_max3_f32 v5, v5, v134, v135
    s_waitcnt lgkmcnt(8)
    v_mfma_f32_32x32x16_bf16 v[120:135], v[80:83], v[16:19], 0
    v_max3_f32 v4, v4, v136, v137
    v_max3_f32 v5, v5, v138, v139
    v_max3_f32 v4, v4, v140, v141
    v_max3_f32 v5, v5, v142, v143
    v_mfma_f32_32x32x16_bf16 v[120:135], v[84:87], v[20:23], v[120:135]
    v_max3_f32 v4, v4, v144, v145
    v_max3_f32 v5, v5, v146, v147
    v_max3_f32 v4, v4, v148, v149
    v_max3_f32 v5, v5, v150, v151
    s_cmp_gt_u32 s95, 4
    s_cbranch_scc0 Lh_35
    s_waitcnt lgkmcnt(6)
    v_mfma_f32_32x32x16_bf16 v[136:151], v[88:91], v[16:19], 0
    v_max3_f32 v4, v4, v152, v153
    v_max3_f32 v5, v5, v154, v155
    v_max3_f32 v4, v4, v156, v157
    v_max3_f32 v5, v5, v158, v159
    v_mfma_f32_32x32x16_bf16 v[136:151], v[92:95], v[20:23], v[136:151]
    v_max3_f32 v4, v4, v160, v161
    v_max3_f32 v5, v5, v162, v163
    v_max3_f32 v4, v4, v164, v165
    v_max3_f32 v5, v5, v166, v167
    s_cmp_gt_u32 s95, 5
    s_cbranch_scc0 Lh_36
    s_waitcnt lgkmcnt(4)
    v_mfma_f32_32x32x16_bf16 v[152:167], v[96:99], v[16:19], 0
    v_max3_f32 v4, v4, v120, v121
    v_max3_f32 v5, v5, v122, v123
    v_max3_f32 v4, v4, v124, v125
    v_max3_f32 v5, v5, v126, v127
    v_mfma_f32_32x32x16_bf16 v[152:167], v[100:103], v[20:23], v[152:167]
    v_max3_f32 v4, v4, v128, v129
    v_max3_f32 v5, v5, v130, v131
    v_max3_f32 v4, v4, v132, v133
    v_max3_f32 v5, v5, v134, v135
    s_cmp_gt_u32 s95, 6
    s_cbranch_scc0 Lh_37
    s_waitcnt lgkmcnt(2)
    v_mfma_f32_32x32x16_bf16 v[120:135], v[104:107], v[16:19], 0
    v_max3_f32 v4, v4, v136, v137
    v_max3_f32 v5, v5, v138, v139
    v_max3_f32 v4, v4, v140, v141
    v_max3_f32 v5, v5, v142, v143
    v_mfma_f32_32x32x16_bf16 v[120:135], v[108:111], v[20:23], v[120:135]
    v_max3_f32 v4, v4, v144, v145
    v_max3_f32 v5, v5, v146, v147
    v_max3_f32 v4, v4, v148, v149
    v_max3_f32 v5, v5, v150, v151
    s_cmp_gt_u32 s95, 7
    s_cbranch_scc0 Lh_38
    s_waitcnt lgkmcnt(0)
    v_mfma_f32_32x32x16_bf16 v[136:151], v[112:115], v[16:19], 0
    v_max3_f32 v4, v4, v152, v153
    v_max3_f32 v5, v5, v154, v155
    v_max3_f32 v4, v4, v156, v157
    v_max3_f32 v5, v5, v158, v159
    v_mfma_f32_32x32x16_bf16 v[136:151], v[116:119], v[20:23], v[136:151]
    v_max3_f32 v4, v4, v160, v161
    v_max3_f32 v5, v5, v162, v163
    v_max3_f32 v4, v4, v164, v165
    v_max3_f32 v5, v5, v166, v167
    v_max3_f32 v4, v4, v120, v121
    v_max3_f32 v5, v5, v122, v123
    v_max3_f32 v4, v4, v124, v125
    v_max3_f32 v5, v5, v126, v127
    v_max3_f32 v4, v4, v128, v129
    v_max3_f32 v5, v5, v130, v131
    v_max3_f32 v4, v4, v132, v133
    v_max3_f32 v5, v5, v134, v135
    v_max3_f32 v4, v4, v136, v137
    v_max3_f32 v5, v5, v138, v139
    v_max3_f32 v4, v4, v140, v141
    v_max3_f32 v5, v5, v142, v143
    v_max3_f32 v4, v4, v144, v145
    v_max3_f32 v5, v5, v146, v147
    v_max3_f32 v4, v4, v148, v149
    v_max3_f32 v5, v5, v150, v151
    s_branch Lh_39
Lh_38:
    v_max3_f32 v4, v4, v152, v153
    v_max3_f32 v5, v5, v154, v155
    v_max3_f32 v4, v4, v156, v157
    v_max3_f32 v5, v5, v158, v159
    v_max3_f32 v4, v4, v160, v161
    v_max3_f32 v5, v5, v162, v163
    v_max3_f32 v4, v4, v164, v165
    v_max3_f32 v5, v5, v166, v167
    v_max3_f32 v4, v4, v120, v121
    v_max3_f32 v5, v5, v122, v123
    v_max3_f32 v4, v4, v124, v125
    v_max3_f32 v5, v5, v126, v127
    v_max3_f32 v4, v4, v128, v129
    v_max3_f32 v5, v5, v130, v131
    v_max3_f32 v4, v4, v132, v133
    v_max3_f32 v5, v5, v134, v135
    s_branch Lh_39
Lh_37:
    v_max3_f32 v4, v4, v136, v137
    v_max3_f32 v5, v5, v138, v139
    v_max3_f32 v4, v4, v140, v141
    v_max3_f32 v5, v5, v142, v143
    v_max3_f32 v4, v4, v144, v145
    v_max3_f32 v5, v5, v146, v147
    v_max3_f32 v4, v4, v148, v149
    v_max3_f32 v5, v5, v150, v151
    v_max3_f32 v4, v4, v152, v153
    v_max3_f32 v5, v5, v154, v155
    v_max3_f32 v4, v4, v156, v157
    v_max3_f32 v5, v5, v158, v159
    v_max3_f32 v4, v4, v160, v161
    v_max3_f32 v5, v5, v162, v163
    v_max3_f32 v4, v4, v164, v165
    v_max3_f32 v5, v5, v166, v167
    s_branch Lh_39
Lh_36:
    v_max3_f32 v4, v4, v120, v121
    v_max3_f32 v5, v5, v122, v123
    v_max3_f32 v4, v4, v124, v125
    v_max3_f32 v5, v5, v126, v127
    v_max3_f32 v4, v4, v128, v129
    v_max3_f32 v5, v5, v130, v131
    v_max3_f32 v4, v4, v132, v133
    v_max3_f32 v5, v5, v134, v135
    v_max3_f32 v4, v4, v136, v137
    v_max3_f32 v5, v5, v138, v139
    v_max3_f32 v4, v4, v140, v141
    v_max3_f32 v5, v5, v142, v143
    v_max3_f32 v4, v4, v144, v145
    v_max3_f32 v5, v5, v146, v147
    v_max3_f32 v4, v4, v148, v149
    v_max3_f32 v5, v5, v150, v151
    s_branch Lh_39
Lh_35:
    v_max3_f32 v4, v4, v152, v153
    v_max3_f32 v5, v5, v154, v155
    v_max3_f32 v4, v4, v156, v157
    v_max3_f32 v5, v5, v158, v159
    v_max3_f32 v4, v4, v160, v161
    v_max3_f32 v5, v5, v162, v163
    v_max3_f32 v4, v4, v164, v165
    v_max3_f32 v5, v5, v166, v167
    v_max3_f32 v4, v4, v120, v121
    v_max3_f32 v5, v5, v122, v123
    v_max3_f32 v4, v4, v124, v125
    v_max3_f32 v5, v5, v126, v127
    v_max3_f32 v4, v4, v128, v129
    v_max3_f32 v5, v5, v130, v131
    v_max3_f32 v4, v4, v132, v133
    v_max3_f32 v5, v5, v134, v135
Lh_39:
    v_max_f32 v4, v4, v5
    v_mov_b32 v5, v4
    s_waitcnt lgkmcnt(0)
    ds_read_b128 v[184:187], v2 offset:0
    ds_read_b128 v[188:191], v2 offset:1024
    ds_read_b128 v[192:195], v3 offset:14336
    ds_read_b128 v[196:199], v3 offset:15360
    s_cmp_lt_u32 s3, 4
    s_cbranch_scc0 Ls_40
    s_barrier
Ls_40:
    v_permlane32_swap_b32 v4, v5
    v_max_f32 v4, v4, v5
    v_sub_f32 v120, v40, v4
    v_sub_f32 v121, v41, v4
    v_sub_f32 v122, v42, v4
    v_sub_f32 v123, v43, v4
    v_sub_f32 v124, v44, v4
    v_sub_f32 v125, v45, v4
    v_sub_f32 v126, v46, v4
    v_sub_f32 v127, v47, v4
    v_sub_f32 v128, v48, v4
    v_sub_f32 v129, v49, v4
    v_sub_f32 v130, v50, v4
    v_sub_f32 v131, v51, v4
    v_sub_f32 v132, v52, v4
    v_sub_f32 v133, v53, v4
    v_sub_f32 v134, v54, v4
    v_sub_f32 v135, v55, v4
    v_sub_f32 v13, v12, v4
    v_sub_f32 v168, 0, v4
    v_mfma_f32_32x32x16_bf16 v[120:135], v[56:59], v[16:19], v[120:135]
    v_exp_f32 v13, v13
    v_mov_b32 v169, v168
    v_mov_b32 v170, v168
    v_mov_b32 v171, v168
    v_mov_b32 v172, v168
    v_mov_b32 v173, v168
    v_mfma_f32_32x32x16_bf16 v[120:135], v[60:63], v[20:23], v[120:135]
    v_mov_b32 v174, v168
    v_mov_b32 v175, v168
    v_mov_b32 v176, v168
    v_mov_b32 v177, v168
    v_mov_b32 v178, v168
    v_mov_b32 v179, v168
    v_mov_b32 v180, v168
    v_mov_b32 v181, v168
    v_mov_b32 v182, v168
    v_mov_b32 v183, v168
    v_mul_f32 v8, v8, v13
    v_mul_f32 v24, v24, v13
    v_mul_f32 v25, v25, v13
    v_mul_f32 v26, v26, v13
    v_mul_f32 v27, v27, v13
    v_mul_f32 v28, v28, v13
    v_mul_f32 v29, v29, v13
    v_mul_f32 v30, v30, v13
    v_mul_f32 v31, v31, v13
    v_mul_f32 v32, v32, v13
    v_mul_f32 v33, v33, v13
    v_mul_f32 v34, v34, v13
    v_mul_f32 v35, v35, v13
    v_mul_f32 v36, v36, v13
    v_mul_f32 v37, v37, v13
    v_mul_f32 v38, v38, v13
    v_mul_f32 v39, v39, v13
    v_exp_f32 v120, v120
    v_exp_f32 v121, v121
    v_exp_f32 v122, v122
    v_exp_f32 v123, v123
    v_exp_f32 v124, v124
    v_mfma_f32_32x32x16_bf16 v[136:151], v[64:67], v[16:19], v[168:183]
    v_exp_f32 v125, v125
    v_exp_f32 v126, v126
    v_exp_f32 v127, v127
    v_cvt_pk_bf16_f32 v120, v120, v121
    v_cvt_pk_bf16_f32 v121, v122, v123
    v_cvt_pk_bf16_f32 v122, v124, v125
    v_cvt_pk_bf16_f32 v123, v126, v127
    v_mfma_f32_32x32x16_bf16 v[136:151], v[68:71], v[20:23], v[136:151]
    v_exp_f32 v128, v128
    v_exp_f32 v129, v129
    v_exp_f32 v130, v130
    s_waitcnt lgkmcnt(2)
    v_mfma_f32_32x32x16_bf16 v[24:39], v[184:187], v[120:123], v[24:39]
    v_exp_f32 v131, v131
    v_exp_f32 v132, v132
    v_exp_f32 v133, v133
    v_mfma_f32_16x16x32_bf16 v[8:11], v[236:239], v[120:123], v[8:11]
    v_exp_f32 v134, v134
    v_exp_f32 v135, v135
    v_cvt_pk_bf16_f32 v128, v128, v129
    v_cvt_pk_bf16_f32 v129, v130, v131
    v_cvt_pk_bf16_f32 v130, v132, v133
    v_cvt_pk_bf16_f32 v131, v134, v135
    v_exp_f32 v136, v136
    v_exp_f32 v137, v137
    v_mfma_f32_32x32x16_bf16 v[24:39], v[188:191], v[128:131], v[24:39]
    v_exp_f32 v138, v138
    v_exp_f32 v139, v139
    v_exp_f32 v140, v140
    v_mfma_f32_32x32x16_bf16 v[152:167], v[72:75], v[16:19], v[168:183]
    ds_read_b128 v[184:187], v3 offset:12288
    ds_read_b128 v[188:191], v3 offset:13312
    v_exp_f32 v141, v141
    v_exp_f32 v142, v142
    v_mfma_f32_16x16x32_bf16 v[8:11], v[236:239], v[128:131], v[8:11]
    v_exp_f32 v143, v143
    v_cvt_pk_bf16_f32 v136, v136, v137
    v_cvt_pk_bf16_f32 v137, v138, v139
    v_cvt_pk_bf16_f32 v138, v140, v141
    v_cvt_pk_bf16_f32 v139, v142, v143
    v_mfma_f32_32x32x16_bf16 v[152:167], v[76:79], v[20:23], v[152:167]
    v_exp_f32 v144, v144
    v_exp_f32 v145, v145
    v_exp_f32 v146, v146
    s_waitcnt lgkmcnt(2)
    v_mfma_f32_32x32x16_bf16 v[24:39], v[192:195], v[136:139], v[24:39]
    v_exp_f32 v147, v147
    v_exp_f32 v148, v148
    v_exp_f32 v149, v149
    v_mfma_f32_16x16x32_bf16 v[8:11], v[236:239], v[136:139], v[8:11]
    v_exp_f32 v150, v150
    v_exp_f32 v151, v151
    v_cvt_pk_bf16_f32 v144, v144, v145
    v_cvt_pk_bf16_f32 v145, v146, v147
    v_cvt_pk_bf16_f32 v146, v148, v149
    v_cvt_pk_bf16_f32 v147, v150, v151
    v_exp_f32 v152, v152
    v_exp_f32 v153, v153
    v_mfma_f32_32x32x16_bf16 v[24:39], v[196:199], v[144:147], v[24:39]
    v_exp_f32 v154, v154
    v_exp_f32 v155, v155
    v_exp_f32 v156, v156
    v_mfma_f32_32x32x16_bf16 v[120:135], v[80:83], v[16:19], v[168:183]
    ds_read_b128 v[192:195], v3 offset:10240
    ds_read_b128 v[196:199], v3 offset:11264
    v_exp_f32 v157, v157
    v_exp_f32 v158, v158
    v_mfma_f32_16x16x32_bf16 v[8:11], v[236:239], v[144:147], v[8:11]
    v_exp_f32 v159, v159
    v_cvt_pk_bf16_f32 v152, v152, v153
    v_cvt_pk_bf16_f32 v153, v154, v155
    v_cvt_pk_bf16_f32 v154, v156, v157
    v_cvt_pk_bf16_f32 v155, v158, v159
    v_mfma_f32_32x32x16_bf16 v[120:135], v[84:87], v[20:23], v[120:135]
    v_exp_f32 v160, v160
    v_exp_f32 v161, v161
    v_exp_f32 v162, v162
    s_waitcnt lgkmcnt(2)
    v_mfma_f32_32x32x16_bf16 v[24:39], v[184:187], v[152:155], v[24:39]
    v_exp_f32 v163, v163
    v_exp_f32 v164, v164
    v_exp_f32 v165, v165
    v_mfma_f32_16x16x32_bf16 v[8:11], v[236:239], v[152:155], v[8:11]
    v_exp_f32 v166, v166
    v_exp_f32 v167, v167
    v_cvt_pk_bf16_f32 v160, v160, v161
    v_cvt_pk_bf16_f32 v161, v162, v163
    v_cvt_pk_bf16_f32 v162, v164, v165
    v_cvt_pk_bf16_f32 v163, v166, v167
    v_exp_f32 v120, v120
    v_exp_f32 v121, v121
    v_mfma_f32_32x32x16_bf16 v[24:39], v[188:191], v[160:163], v[24:39]
    v_exp_f32 v122, v122
    v_exp_f32 v123, v123
    v_exp_f32 v124, v124
    v_mfma_f32_32x32x16_bf16 v[136:151], v[88:91], v[16:19], v[168:183]
    ds_read_b128 v[184:187], v3 offset:8192
    ds_read_b128 v[188:191], v3 offset:9216
    v_exp_f32 v125, v125
    v_exp_f32 v126, v126
    v_mfma_f32_16x16x32_bf16 v[8:11], v[236:239], v[160:163], v[8:11]
    v_exp_f32 v127, v127
    v_cvt_pk_bf16_f32 v120, v120, v121
    v_cvt_pk_bf16_f32 v121, v122, v123
    v_cvt_pk_bf16_f32 v122, v124, v125
    v_cvt_pk_bf16_f32 v123, v126, v127
    v_mfma_f32_32x32x16_bf16 v[136:151], v[92:95], v[20:23], v[136:151]
    v_exp_f32 v128, v128
    v_exp_f32 v129, v129
    v_exp_f32 v130, v130
    s_waitcnt lgkmcnt(2)
    v_mfma_f32_32x32x16_bf16 v[24:39], v[192:195], v[120:123], v[24:39]
    v_exp_f32 v131, v131
    v_exp_f32 v132, v132
    v_exp_f32 v133, v133
    v_mfma_f32_16x16x32_bf16 v[8:11], v[236:239], v[120:123], v[8:11]
    v_exp_f32 v134, v134
    v_exp_f32 v135, v135
    v_cvt_pk_bf16_f32 v128, v128, v129
    v_cvt_pk_bf16_f32 v129, v130, v131
    v_cvt_pk_bf16_f32 v130, v132, v133
    v_cvt_pk_bf16_f32 v131, v134, v135
    s_cmp_gt_u32 s95, 4
    s_cbranch_scc0 Lh_41
    v_exp_f32 v136, v136
    v_exp_f32 v137, v137
    v_mfma_f32_32x32x16_bf16 v[24:39], v[196:199], v[128:131], v[24:39]
    v_exp_f32 v138, v138
    v_exp_f32 v139, v139
    v_exp_f32 v140, v140
    v_mfma_f32_32x32x16_bf16 v[152:167], v[96:99], v[16:19], v[168:183]
    ds_read_b128 v[192:195], v3 offset:6144
    ds_read_b128 v[196:199], v3 offset:7168
    v_exp_f32 v141, v141
    v_exp_f32 v142, v142
    v_mfma_f32_16x16x32_bf16 v[8:11], v[236:239], v[128:131], v[8:11]
    v_exp_f32 v143, v143
    v_cvt_pk_bf16_f32 v136, v136, v137
    v_cvt_pk_bf16_f32 v137, v138, v139
    v_cvt_pk_bf16_f32 v138, v140, v141
    v_cvt_pk_bf16_f32 v139, v142, v143
    v_mfma_f32_32x32x16_bf16 v[152:167], v[100:103], v[20:23], v[152:167]
    v_exp_f32 v144, v144
    v_exp_f32 v145, v145
    v_exp_f32 v146, v146
    s_waitcnt lgkmcnt(2)
    v_mfma_f32_32x32x16_bf16 v[24:39], v[184:187], v[136:139], v[24:39]
    v_exp_f32 v147, v147
    v_exp_f32 v148, v148
    v_exp_f32 v149, v149
    v_mfma_f32_16x16x32_bf16 v[8:11], v[236:239], v[136:139], v[8:11]
    v_exp_f32 v150, v150
    v_exp_f32 v151, v151
    v_cvt_pk_bf16_f32 v144, v144, v145
    v_cvt_pk_bf16_f32 v145, v146, v147
    v_cvt_pk_bf16_f32 v146, v148, v149
    v_cvt_pk_bf16_f32 v147, v150, v151
    s_cmp_gt_u32 s95, 5
    s_cbranch_scc0 Lh_42
    v_exp_f32 v152, v152
    v_exp_f32 v153, v153
    v_mfma_f32_32x32x16_bf16 v[24:39], v[188:191], v[144:147], v[24:39]
    v_exp_f32 v154, v154
    v_exp_f32 v155, v155
    v_exp_f32 v156, v156
    v_mfma_f32_32x32x16_bf16 v[120:135], v[104:107], v[16:19], v[168:183]
    ds_read_b128 v[184:187], v3 offset:4096
    ds_read_b128 v[188:191], v3 offset:5120
    v_exp_f32 v157, v157
    v_exp_f32 v158, v158
    v_mfma_f32_16x16x32_bf16 v[8:11], v[236:239], v[144:147], v[8:11]
    v_exp_f32 v159, v159
    v_cvt_pk_bf16_f32 v152, v152, v153
    v_cvt_pk_bf16_f32 v153, v154, v155
    v_cvt_pk_bf16_f32 v154, v156, v157
    v_cvt_pk_bf16_f32 v155, v158, v159
    v_mfma_f32_32x32x16_bf16 v[120:135], v[108:111], v[20:23], v[120:135]
    v_exp_f32 v160, v160
    v_exp_f32 v161, v161
    v_exp_f32 v162, v162
    s_waitcnt lgkmcnt(2)
    v_mfma_f32_32x32x16_bf16 v[24:39], v[192:195], v[152:155], v[24:39]
    v_exp_f32 v163, v163
    v_exp_f32 v164, v164
    v_exp_f32 v165, v165
    v_mfma_f32_16x16x32_bf16 v[8:11], v[236:239], v[152:155], v[8:11]
    v_exp_f32 v166, v166
    v_exp_f32 v167, v167
    v_cvt_pk_bf16_f32 v160, v160, v161
    v_cvt_pk_bf16_f32 v161, v162, v163
    v_cvt_pk_bf16_f32 v162, v164, v165
    v_cvt_pk_bf16_f32 v163, v166, v167
    s_cmp_gt_u32 s95, 6
    s_cbranch_scc0 Lh_43
    v_exp_f32 v120, v120
    v_exp_f32 v121, v121
    v_mfma_f32_32x32x16_bf16 v[24:39], v[196:199], v[160:163], v[24:39]
    v_exp_f32 v122, v122
    v_exp_f32 v123, v123
    v_exp_f32 v124, v124
    v_mfma_f32_32x32x16_bf16 v[136:151], v[112:115], v[16:19], v[168:183]
    ds_read_b128 v[192:195], v3 offset:2048
    ds_read_b128 v[196:199], v3 offset:3072
    v_exp_f32 v125, v125
    v_exp_f32 v126, v126
    v_mfma_f32_16x16x32_bf16 v[8:11], v[236:239], v[160:163], v[8:11]
    v_exp_f32 v127, v127
    v_cvt_pk_bf16_f32 v120, v120, v121
    v_cvt_pk_bf16_f32 v121, v122, v123
    v_cvt_pk_bf16_f32 v122, v124, v125
    v_cvt_pk_bf16_f32 v123, v126, v127
    v_mfma_f32_32x32x16_bf16 v[136:151], v[116:119], v[20:23], v[136:151]
    v_exp_f32 v128, v128
    v_exp_f32 v129, v129
    v_exp_f32 v130, v130
    s_waitcnt lgkmcnt(2)
    v_mfma_f32_32x32x16_bf16 v[24:39], v[184:187], v[120:123], v[24:39]
    v_exp_f32 v131, v131
    v_exp_f32 v132, v132
    v_exp_f32 v133, v133
    v_mfma_f32_16x16x32_bf16 v[8:11], v[236:239], v[120:123], v[8:11]
    v_exp_f32 v134, v134
    v_exp_f32 v135, v135
    v_cvt_pk_bf16_f32 v128, v128, v129
    v_cvt_pk_bf16_f32 v129, v130, v131
    v_cvt_pk_bf16_f32 v130, v132, v133
    v_cvt_pk_bf16_f32 v131, v134, v135
    s_cmp_gt_u32 s95, 7
    s_cbranch_scc0 Lh_44
    v_exp_f32 v136, v136
    v_exp_f32 v137, v137
    v_mfma_f32_32x32x16_bf16 v[24:39], v[188:191], v[128:131], v[24:39]
    v_exp_f32 v138, v138
    v_exp_f32 v139, v139
    v_exp_f32 v140, v140
    v_exp_f32 v141, v141
    v_exp_f32 v142, v142
    v_mfma_f32_16x16x32_bf16 v[8:11], v[236:239], v[128:131], v[8:11]
    v_exp_f32 v143, v143
    v_cvt_pk_bf16_f32 v136, v136, v137
    v_cvt_pk_bf16_f32 v137, v138, v139
    v_cvt_pk_bf16_f32 v138, v140, v141
    v_cvt_pk_bf16_f32 v139, v142, v143
    v_exp_f32 v144, v144
    v_exp_f32 v145, v145
    v_exp_f32 v146, v146
    s_waitcnt lgkmcnt(0)
    v_mfma_f32_32x32x16_bf16 v[24:39], v[192:195], v[136:139], v[24:39]
    v_exp_f32 v147, v147
    v_exp_f32 v148, v148
    v_exp_f32 v149, v149
    v_mfma_f32_16x16x32_bf16 v[8:11], v[236:239], v[136:139], v[8:11]
    v_exp_f32 v150, v150
    v_exp_f32 v151, v151
    v_cvt_pk_bf16_f32 v144, v144, v145
    v_cvt_pk_bf16_f32 v145, v146, v147
    v_cvt_pk_bf16_f32 v146, v148, v149
    v_cvt_pk_bf16_f32 v147, v150, v151
    s_nop 1
    v_mfma_f32_32x32x16_bf16 v[24:39], v[196:199], v[144:147], v[24:39]
    v_mfma_f32_16x16x32_bf16 v[8:11], v[236:239], v[144:147], v[8:11]
    s_branch Lh_45
Lh_44:
    v_mfma_f32_32x32x16_bf16 v[24:39], v[188:191], v[128:131], v[24:39]
    v_mfma_f32_16x16x32_bf16 v[8:11], v[236:239], v[128:131], v[8:11]
    s_branch Lh_45
Lh_43:
    v_mfma_f32_32x32x16_bf16 v[24:39], v[196:199], v[160:163], v[24:39]
    v_mfma_f32_16x16x32_bf16 v[8:11], v[236:239], v[160:163], v[8:11]
    s_branch Lh_45
Lh_42:
    v_mfma_f32_32x32x16_bf16 v[24:39], v[188:191], v[144:147], v[24:39]
    v_mfma_f32_16x16x32_bf16 v[8:11], v[236:239], v[144:147], v[8:11]
    s_branch Lh_45
Lh_41:
    v_mfma_f32_32x32x16_bf16 v[24:39], v[196:199], v[128:131], v[24:39]
    v_mfma_f32_16x16x32_bf16 v[8:11], v[236:239], v[128:131], v[8:11]
Lh_45:
    s_branch Lfin_33
Lno_34:
    s_waitcnt lgkmcnt(0)
    s_cmp_lt_u32 s3, 4
    s_cbranch_scc0 Lfin_33
    s_barrier
Lfin_33:
    s_nop 6
    v_rcp_f32 v8, v8
    s_nop 1
    v_mul_f32 v24, v24, v8
    v_mul_f32 v25, v25, v8
    v_mul_f32 v26, v26, v8
    v_mul_f32 v27, v27, v8
    v_mul_f32 v28, v28, v8
    v_mul_f32 v29, v29, v8
    v_mul_f32 v30, v30, v8
    v_mul_f32 v31, v31, v8
    v_cvt_pk_bf16_f32 v168, v24, v25
    v_cvt_pk_bf16_f32 v169, v26, v27
    v_cvt_pk_bf16_f32 v170, v28, v29
    v_cvt_pk_bf16_f32 v171, v30, v31
    v_mul_f32 v32, v32, v8
    v_mul_f32 v33, v33, v8
    v_mul_f32 v34, v34, v8
    v_mul_f32 v35, v35, v8
    v_mul_f32 v36, v36, v8
    v_mul_f32 v37, v37, v8
    v_mul_f32 v38, v38, v8
    v_mul_f32 v39, v39, v8
    v_cvt_pk_bf16_f32 v172, v32, v33
    v_cvt_pk_bf16_f32 v173, v34, v35
    v_cvt_pk_bf16_f32 v174, v36, v37
    v_cvt_pk_bf16_f32 v175, v38, v39
    buffer_store_dwordx4 v[168:171], v6, s[56:59], 0 offen offset:0 sc1
    buffer_store_dwordx4 v[172:175], v6, s[56:59], 0 offen offset:512 sc1
    s_setprio 0
    s_cmp_lt_u32 s3, 4
    s_cbranch_scc1 L_lo2
    s_lshl_b32 s93, s79, 2
    s_and_b32 s90, s3, 1
    s_add_u32 s93, s93, s90
    s_add_u32 s93, s93, 2
    s_lshl_b32 s90, s93, 1
    s_add_u32 s90, s90, s84
    s_lshl_b32 s90, s90, 11
    s_add_u32 s90, s90, 0x1020000
    v_lshl_add_u32 v22, v0, 7, s90
    v_lshrrev_b32 v17, 2, v0
    v_and_b32 v17, 7, v17
    v_lshrrev_b32 v18, 1, v17
    v_lshlrev_b32 v18, 5, v18
    v_lshl_add_u32 v16, v17, 7, v18
    v_and_b32 v17, 32, v0
    v_lshl_add_u32 v16, v17, 6, v16
    v_and_b32 v17, 3, v0
    v_lshl_add_u32 v16, v17, 3, v16
    s_lshl_b32 s90, s84, 16
    s_add_u32 s90, s90, 32768
    v_add_u32 v16, s90, v16
    v_xor_b32 v17, 32, v16
    v_xor_b32 v18, 64, v16
    v_xor_b32 v19, 96, v16
    s_lshl_b32 s90, s93, 16
    s_lshl_b32 s91, s84, 14
    s_add_u32 s90, s90, s91
    s_add_u32 s90, s90, 0x800000
    v_add_u32 v20, s90, v1
    v_add_u32 v21, 0x8000, v20
    s_add_u32 s92, s87, s85
    s_lshl_b32 s92, s92, 5
    s_add_u32 s92, s92, s86
    s_lshl_b32 s92, s92, 7
    s_add_u32 s92, s92, 0x1020000
    s_waitcnt vmcnt(2) lgkmcnt(0)
    s_barrier
    s_mov_b64 exec, 0xffff
    buffer_load_dword v253, v22, s[56:59], 0 offen sc1
    s_mov_b64 exec, -1
    s_mul_i32 s72, s94, 2
    s_add_u32 s72, s72, 120
    s_lshl_b32 s73, s72, 10
    s_add_u32 m0, s73, 32768
    s_lshl_b32 s72, s72, 14
    buffer_load_dwordx4 v14, s[36:39], s72 offen lds
    buffer_load_dwordx4 v15, s[36:39], s72 offen offset:1024 lds
    s_add_u32 m0, m0, 2048
    s_add_u32 s72, s72, 32768
    ds_read_b64_tr_b16 v[152:153], v16 offset:0
    ds_read_b64_tr_b16 v[154:155], v16 offset:1024
    ds_read_b64_tr_b16 v[156:157], v17 offset:0
    ds_read_b64_tr_b16 v[158:159], v17 offset:1024
    ds_read_b64_tr_b16 v[160:161], v18 offset:0
    ds_read_b64_tr_b16 v[162:163], v18 offset:1024
    ds_read_b64_tr_b16 v[164:165], v19 offset:0
    ds_read_b64_tr_b16 v[166:167], v19 offset:1024
    ds_read_b64_tr_b16 v[168:169], v16 offset:4096
    ds_read_b64_tr_b16 v[170:171], v16 offset:5120
    ds_read_b64_tr_b16 v[172:173], v17 offset:4096
    ds_read_b64_tr_b16 v[174:175], v17 offset:5120
    ds_read_b64_tr_b16 v[176:177], v18 offset:4096
    ds_read_b64_tr_b16 v[178:179], v18 offset:5120
    ds_read_b64_tr_b16 v[180:181], v19 offset:4096
    ds_read_b64_tr_b16 v[182:183], v19 offset:5120
    s_lshl_b32 s90, s3, 12
    v_add_u32 v24, s90, v1
    v_xor_b32 v25, 0x2000, v24
    v_and_b32 v26, 15, v0
    v_lshrrev_b32 v27, 3, v0
    v_and_b32 v27, 2, v27
    v_lshrrev_b32 v28, 5, v0
    v_or_b32 v27, v27, v28
    v_and_b32 v28, 7, v0
    v_xor_b32 v27, v27, v28
    v_lshlrev_b32 v27, 4, v27
    v_lshl_add_u32 v26, v26, 7, v27
    s_xor_b32 s90, s90, 0x2000
    v_add_u32 v26, s90, v26
    v_xor_b32 v27, 64, v26
    v_lshrrev_b32 v29, 3, v0
    v_xor_b32 v28, v28, v29
    v_lshlrev_b32 v28, 4, v28
    v_lshl_add_u32 v28, v29, 12, v28
    s_lshl_b32 s72, s93, 17
    s_lshl_b32 s91, s84, 16
    s_add_u32 s72, s72, s91
    s_lshl_b32 s91, s78, 7
    s_add_u32 s72, s72, s91
    s_add_u32 s73, s72, 32768
    s_waitcnt vmcnt(3)
    v_lshl_add_u32 v250, v0, 2, s92
    v_mov_b32 v251, s89
    s_mov_b32 exec_hi, 0
    buffer_store_dword v251, v250, s[56:59], 0 offen sc1
    s_mov_b32 exec_hi, -1
    s_barrier
    s_waitcnt vmcnt(3)
    s_mov_b64 exec, 0xffff
    v_cmp_ne_u32 vcc, s89, v253
    s_mov_b64 exec, -1
    s_cbranch_vccz Lo_46
    s_mov_b32 s96, 0
    s_mov_b64 exec, 0xffff
Lp_47:
    buffer_load_dword v253, v22, s[56:59], 0 offen sc1
Lpe_49:
    s_add_u32 s96, s96, 1
    s_waitcnt vmcnt(0)
    v_cmp_ne_u32 vcc, s89, v253
    s_cmp_ge_u32 s96, 32768
    s_cbranch_scc1 Lpd_48
    s_cbranch_vccz Lpd_48
    s_sleep 2
    s_branch Lp_47
Lpd_48:
    s_mov_b64 exec, -1
Lo_46:
    s_mov_b32 s91, 0
    buffer_load_dwordx4 v[200:203], v20, s[56:59], s91 offen offset:0 sc1
    buffer_load_dwordx4 v[204:207], v21, s[56:59], s91 offen offset:0 sc1
    buffer_load_dwordx4 v[208:211], v20, s[56:59], s91 offen offset:1024 sc1
    buffer_load_dwordx4 v[212:215], v21, s[56:59], s91 offen offset:1024 sc1
    buffer_load_dwordx4 v[216:219], v20, s[56:59], s91 offen offset:2048 sc1
    buffer_load_dwordx4 v[220:223], v21, s[56:59], s91 offen offset:2048 sc1
    buffer_load_dwordx4 v[224:227], v20, s[56:59], s91 offen offset:3072 sc1
    buffer_load_dwordx4 v[228:231], v21, s[56:59], s91 offen offset:3072 sc1
    s_mov_b32 s91, 4096
    buffer_load_dwordx4 v[232:235], v20, s[56:59], s91 offen offset:0 sc1
    buffer_load_dwordx4 v[236:239], v21, s[56:59], s91 offen offset:0 sc1
    s_waitcnt vmcnt(8) lgkmcnt(8)
    v_mfma_f32_16x16x32_bf16 v[120:123], v[152:155], v[200:203], 0
    ds_read_b64_tr_b16 v[184:185], v16 offset:8192
    ds_read_b64_tr_b16 v[186:187], v16 offset:9216
    v_mfma_f32_16x16x32_bf16 v[124:127], v[156:159], v[200:203], 0
    ds_read_b64_tr_b16 v[188:189], v17 offset:8192
    ds_read_b64_tr_b16 v[190:191], v17 offset:9216
    v_mfma_f32_16x16x32_bf16 v[128:131], v[160:163], v[200:203], 0
    ds_read_b64_tr_b16 v[192:193], v18 offset:8192
    ds_read_b64_tr_b16 v[194:195], v18 offset:9216
    v_mfma_f32_16x16x32_bf16 v[132:135], v[164:167], v[200:203], 0
    ds_read_b64_tr_b16 v[196:197], v19 offset:8192
    ds_read_b64_tr_b16 v[198:199], v19 offset:9216
    v_mfma_f32_16x16x32_bf16 v[136:139], v[152:155], v[204:207], 0
    buffer_load_dwordx4 v[240:243], v20, s[56:59], s91 offen offset:1024 sc1
    buffer_load_dwordx4 v[244:247], v21, s[56:59], s91 offen offset:1024 sc1
    v_mfma_f32_16x16x32_bf16 v[140:143], v[156:159], v[204:207], 0
    v_mfma_f32_16x16x32_bf16 v[144:147], v[160:163], v[204:207], 0
    v_mfma_f32_16x16x32_bf16 v[148:151], v[164:167], v[204:207], 0
    s_waitcnt vmcnt(8) lgkmcnt(8)
    v_mfma_f32_16x16x32_bf16 v[120:123], v[168:171], v[208:211], v[120:123]
    ds_read_b64_tr_b16 v[152:153], v16 offset:12288
    ds_read_b64_tr_b16 v[154:155], v16 offset:13312
    v_mfma_f32_16x16x32_bf16 v[124:127], v[172:175], v[208:211], v[124:127]
    ds_read_b64_tr_b16 v[156:157], v17 offset:12288
    ds_read_b64_tr_b16 v[158:159], v17 offset:13312
    v_mfma_f32_16x16x32_bf16 v[128:131], v[176:179], v[208:211], v[128:131]
    ds_read_b64_tr_b16 v[160:161], v18 offset:12288
    ds_read_b64_tr_b16 v[162:163], v18 offset:13312
    v_mfma_f32_16x16x32_bf16 v[132:135], v[180:183], v[208:211], v[132:135]
    ds_read_b64_tr_b16 v[164:165], v19 offset:12288
    ds_read_b64_tr_b16 v[166:167], v19 offset:13312
    v_mfma_f32_16x16x32_bf16 v[136:139], v[168:171], v[212:215], v[136:139]
    buffer_load_dwordx4 v[200:203], v20, s[56:59], s91 offen offset:2048 sc1
    buffer_load_dwordx4 v[204:207], v21, s[56:59], s91 offen offset:2048 sc1
    v_mfma_f32_16x16x32_bf16 v[140:143], v[172:175], v[212:215], v[140:143]
    v_mfma_f32_16x16x32_bf16 v[144:147], v[176:179], v[212:215], v[144:147]
    v_mfma_f32_16x16x32_bf16 v[148:151], v[180:183], v[212:215], v[148:151]
    s_waitcnt vmcnt(8) lgkmcnt(8)
    v_mfma_f32_16x16x32_bf16 v[120:123], v[184:187], v[216:219], v[120:123]
    ds_read_b64_tr_b16 v[168:169], v16 offset:16384
    ds_read_b64_tr_b16 v[170:171], v16 offset:17408
    v_mfma_f32_16x16x32_bf16 v[124:127], v[188:191], v[216:219], v[124:127]
    ds_read_b64_tr_b16 v[172:173], v17 offset:16384
    ds_read_b64_tr_b16 v[174:175], v17 offset:17408
    v_mfma_f32_16x16x32_bf16 v[128:131], v[192:195], v[216:219], v[128:131]
    ds_read_b64_tr_b16 v[176:177], v18 offset:16384
    ds_read_b64_tr_b16 v[178:179], v18 offset:17408
    v_mfma_f32_16x16x32_bf16 v[132:135], v[196:199], v[216:219], v[132:135]
    ds_read_b64_tr_b16 v[180:181], v19 offset:16384
    ds_read_b64_tr_b16 v[182:183], v19 offset:17408
    v_mfma_f32_16x16x32_bf16 v[136:139], v[184:187], v[220:223], v[136:139]
    buffer_load_dwordx4 v[208:211], v20, s[56:59], s91 offen offset:3072 sc1
    buffer_load_dwordx4 v[212:215], v21, s[56:59], s91 offen offset:3072 sc1
    v_mfma_f32_16x16x32_bf16 v[140:143], v[188:191], v[220:223], v[140:143]
    v_mfma_f32_16x16x32_bf16 v[144:147], v[192:195], v[220:223], v[144:147]
    v_mfma_f32_16x16x32_bf16 v[148:151], v[196:199], v[220:223], v[148:151]
    s_waitcnt vmcnt(8) lgkmcnt(8)
    v_mfma_f32_16x16x32_bf16 v[120:123], v[152:155], v[224:227], v[120:123]
    ds_read_b64_tr_b16 v[184:185], v16 offset:20480
    ds_read_b64_tr_b16 v[186:187], v16 offset:21504
    v_mfma_f32_16x16x32_bf16 v[124:127], v[156:159], v[224:227], v[124:127]
    ds_read_b64_tr_b16 v[188:189], v17 offset:20480
    ds_read_b64_tr_b16 v[190:191], v17 offset:21504
    v_mfma_f32_16x16x32_bf16 v[128:131], v[160:163], v[224:227], v[128:131]
    ds_read_b64_tr_b16 v[192:193], v18 offset:20480
    ds_read_b64_tr_b16 v[194:195], v18 offset:21504
    v_mfma_f32_16x16x32_bf16 v[132:135], v[164:167], v[224:227], v[132:135]
    ds_read_b64_tr_b16 v[196:197], v19 offset:20480
    ds_read_b64_tr_b16 v[198:199], v19 offset:21504
    v_mfma_f32_16x16x32_bf16 v[136:139], v[152:155], v[228:231], v[136:139]
    s_mov_b32 s91, 8192
    buffer_load_dwordx4 v[216:219], v20, s[56:59], s91 offen offset:0 sc1
    v_mfma_f32_16x16x32_bf16 v[140:143], v[156:159], v[228:231], v[140:143]
    buffer_load_dwordx4 v[220:223], v21, s[56:59], s91 offen offset:0 sc1
    v_mfma_f32_16x16x32_bf16 v[144:147], v[160:163], v[228:231], v[144:147]
    v_mfma_f32_16x16x32_bf16 v[148:151], v[164:167], v[228:231], v[148:151]
    s_waitcnt vmcnt(8) lgkmcnt(8)
    v_mfma_f32_16x16x32_bf16 v[120:123], v[168:171], v[232:235], v[120:123]
    ds_read_b64_tr_b16 v[152:153], v16 offset:24576
    ds_read_b64_tr_b16 v[154:155], v16 offset:25600
    v_mfma_f32_16x16x32_bf16 v[124:127], v[172:175], v[232:235], v[124:127]
    ds_read_b64_tr_b16 v[156:157], v17 offset:24576
    ds_read_b64_tr_b16 v[158:159], v17 offset:25600
    v_mfma_f32_16x16x32_bf16 v[128:131], v[176:179], v[232:235], v[128:131]
    ds_read_b64_tr_b16 v[160:161], v18 offset:24576
    ds_read_b64_tr_b16 v[162:163], v18 offset:25600
    v_mfma_f32_16x16x32_bf16 v[132:135], v[180:183], v[232:235], v[132:135]
    ds_read_b64_tr_b16 v[164:165], v19 offset:24576
    ds_read_b64_tr_b16 v[166:167], v19 offset:25600
    v_mfma_f32_16x16x32_bf16 v[136:139], v[168:171], v[236:239], v[136:139]
    buffer_load_dwordx4 v[224:227], v20, s[56:59], s91 offen offset:1024 sc1
    buffer_load_dwordx4 v[228:231], v21, s[56:59], s91 offen offset:1024 sc1
    v_mfma_f32_16x16x32_bf16 v[140:143], v[172:175], v[236:239], v[140:143]
    v_mfma_f32_16x16x32_bf16 v[144:147], v[176:179], v[236:239], v[144:147]
    v_mfma_f32_16x16x32_bf16 v[148:151], v[180:183], v[236:239], v[148:151]
    s_waitcnt vmcnt(8) lgkmcnt(8)
    v_mfma_f32_16x16x32_bf16 v[120:123], v[184:187], v[240:243], v[120:123]
    ds_read_b64_tr_b16 v[168:169], v16 offset:28672
    ds_read_b64_tr_b16 v[170:171], v16 offset:29696
    v_mfma_f32_16x16x32_bf16 v[124:127], v[188:191], v[240:243], v[124:127]
    ds_read_b64_tr_b16 v[172:173], v17 offset:28672
    ds_read_b64_tr_b16 v[174:175], v17 offset:29696
    v_mfma_f32_16x16x32_bf16 v[128:131], v[192:195], v[240:243], v[128:131]
    ds_read_b64_tr_b16 v[176:177], v18 offset:28672
    ds_read_b64_tr_b16 v[178:179], v18 offset:29696
    v_mfma_f32_16x16x32_bf16 v[132:135], v[196:199], v[240:243], v[132:135]
    ds_read_b64_tr_b16 v[180:181], v19 offset:28672
    ds_read_b64_tr_b16 v[182:183], v19 offset:29696
    v_mfma_f32_16x16x32_bf16 v[136:139], v[184:187], v[244:247], v[136:139]
    buffer_load_dwordx4 v[232:235], v20, s[56:59], s91 offen offset:2048 sc1
    buffer_load_dwordx4 v[236:239], v21, s[56:59], s91 offen offset:2048 sc1
    v_mfma_f32_16x16x32_bf16 v[140:143], v[188:191], v[244:247], v[140:143]
    v_mfma_f32_16x16x32_bf16 v[144:147], v[192:195], v[244:247], v[144:147]
    v_mfma_f32_16x16x32_bf16 v[148:151], v[196:199], v[244:247], v[148:151]
    s_waitcnt vmcnt(8) lgkmcnt(8)
    v_mfma_f32_16x16x32_bf16 v[120:123], v[152:155], v[200:203], v[120:123]
    ds_read_b64_tr_b16 v[184:185], v16 offset:32768
    ds_read_b64_tr_b16 v[186:187], v16 offset:33792
    v_mfma_f32_16x16x32_bf16 v[124:127], v[156:159], v[200:203], v[124:127]
    ds_read_b64_tr_b16 v[188:189], v17 offset:32768
    ds_read_b64_tr_b16 v[190:191], v17 offset:33792
    v_mfma_f32_16x16x32_bf16 v[128:131], v[160:163], v[200:203], v[128:131]
    ds_read_b64_tr_b16 v[192:193], v18 offset:32768
    ds_read_b64_tr_b16 v[194:195], v18 offset:33792
    v_mfma_f32_16x16x32_bf16 v[132:135], v[164:167], v[200:203], v[132:135]
    ds_read_b64_tr_b16 v[196:197], v19 offset:32768
    ds_read_b64_tr_b16 v[198:199], v19 offset:33792
    v_mfma_f32_16x16x32_bf16 v[136:139], v[152:155], v[204:207], v[136:139]
    buffer_load_dwordx4 v[240:243], v20, s[56:59], s91 offen offset:3072 sc1
    buffer_load_dwordx4 v[244:247], v21, s[56:59], s91 offen offset:3072 sc1
    v_mfma_f32_16x16x32_bf16 v[140:143], v[156:159], v[204:207], v[140:143]
    v_mfma_f32_16x16x32_bf16 v[144:147], v[160:163], v[204:207], v[144:147]
    v_mfma_f32_16x16x32_bf16 v[148:151], v[164:167], v[204:207], v[148:151]
    s_waitcnt vmcnt(8) lgkmcnt(8)
    v_mfma_f32_16x16x32_bf16 v[120:123], v[168:171], v[208:211], v[120:123]
    ds_read_b64_tr_b16 v[152:153], v16 offset:36864
    ds_read_b64_tr_b16 v[154:155], v16 offset:37888
    v_mfma_f32_16x16x32_bf16 v[124:127], v[172:175], v[208:211], v[124:127]
    ds_read_b64_tr_b16 v[156:157], v17 offset:36864
    ds_read_b64_tr_b16 v[158:159], v17 offset:37888
    v_mfma_f32_16x16x32_bf16 v[128:131], v[176:179], v[208:211], v[128:131]
    ds_read_b64_tr_b16 v[160:161], v18 offset:36864
    ds_read_b64_tr_b16 v[162:163], v18 offset:37888
    v_mfma_f32_16x16x32_bf16 v[132:135], v[180:183], v[208:211], v[132:135]
    ds_read_b64_tr_b16 v[164:165], v19 offset:36864
    ds_read_b64_tr_b16 v[166:167], v19 offset:37888
    v_mfma_f32_16x16x32_bf16 v[136:139], v[168:171], v[212:215], v[136:139]
    s_mov_b32 s91, 12288
    buffer_load_dwordx4 v[200:203], v20, s[56:59], s91 offen offset:0 sc1
    v_mfma_f32_16x16x32_bf16 v[140:143], v[172:175], v[212:215], v[140:143]
    buffer_load_dwordx4 v[204:207], v21, s[56:59], s91 offen offset:0 sc1
    v_mfma_f32_16x16x32_bf16 v[144:147], v[176:179], v[212:215], v[144:147]
    v_mfma_f32_16x16x32_bf16 v[148:151], v[180:183], v[212:215], v[148:151]
    s_waitcnt vmcnt(8) lgkmcnt(8)
    v_mfma_f32_16x16x32_bf16 v[120:123], v[184:187], v[216:219], v[120:123]
    ds_read_b64_tr_b16 v[168:169], v16 offset:40960
    ds_read_b64_tr_b16 v[170:171], v16 offset:41984
    v_mfma_f32_16x16x32_bf16 v[124:127], v[188:191], v[216:219], v[124:127]
    ds_read_b64_tr_b16 v[172:173], v17 offset:40960
    ds_read_b64_tr_b16 v[174:175], v17 offset:41984
    v_mfma_f32_16x16x32_bf16 v[128:131], v[192:195], v[216:219], v[128:131]
    ds_read_b64_tr_b16 v[176:177], v18 offset:40960
    ds_read_b64_tr_b16 v[178:179], v18 offset:41984
    v_mfma_f32_16x16x32_bf16 v[132:135], v[196:199], v[216:219], v[132:135]
    ds_read_b64_tr_b16 v[180:181], v19 offset:40960
    ds_read_b64_tr_b16 v[182:183], v19 offset:41984
    v_mfma_f32_16x16x32_bf16 v[136:139], v[184:187], v[220:223], v[136:139]
    buffer_load_dwordx4 v[208:211], v20, s[56:59], s91 offen offset:1024 sc1
    buffer_load_dwordx4 v[212:215], v21, s[56:59], s91 offen offset:1024 sc1
    v_mfma_f32_16x16x32_bf16 v[140:143], v[188:191], v[220:223], v[140:143]
    v_mfma_f32_16x16x32_bf16 v[144:147], v[192:195], v[220:223], v[144:147]
    v_mfma_f32_16x16x32_bf16 v[148:151], v[196:199], v[220:223], v[148:151]
    s_waitcnt vmcnt(8) lgkmcnt(8)
    v_mfma_f32_16x16x32_bf16 v[120:123], v[152:155], v[224:227], v[120:123]
    ds_read_b64_tr_b16 v[184:185], v16 offset:45056
    ds_read_b64_tr_b16 v[186:187], v16 offset:46080
    v_mfma_f32_16x16x32_bf16 v[124:127], v[156:159], v[224:227], v[124:127]
    ds_read_b64_tr_b16 v[188:189], v17 offset:45056
    ds_read_b64_tr_b16 v[190:191], v17 offset:46080
    v_mfma_f32_16x16x32_bf16 v[128:131], v[160:163], v[224:227], v[128:131]
    ds_read_b64_tr_b16 v[192:193], v18 offset:45056
    ds_read_b64_tr_b16 v[194:195], v18 offset:46080
    v_mfma_f32_16x16x32_bf16 v[132:135], v[164:167], v[224:227], v[132:135]
    ds_read_b64_tr_b16 v[196:197], v19 offset:45056
    ds_read_b64_tr_b16 v[198:199], v19 offset:46080
    v_mfma_f32_16x16x32_bf16 v[136:139], v[152:155], v[228:231], v[136:139]
    buffer_load_dwordx4 v[216:219], v20, s[56:59], s91 offen offset:2048 sc1
    buffer_load_dwordx4 v[220:223], v21, s[56:59], s91 offen offset:2048 sc1
    v_mfma_f32_16x16x32_bf16 v[140:143], v[156:159], v[228:231], v[140:143]
    v_mfma_f32_16x16x32_bf16 v[144:147], v[160:163], v[228:231], v[144:147]
    v_mfma_f32_16x16x32_bf16 v[148:151], v[164:167], v[228:231], v[148:151]
    s_barrier
    s_waitcnt vmcnt(8) lgkmcnt(8)
    v_mfma_f32_16x16x32_bf16 v[120:123], v[168:171], v[232:235], v[120:123]
    ds_read_b64_tr_b16 v[152:153], v16 offset:49152
    ds_read_b64_tr_b16 v[154:155], v16 offset:50176
    v_mfma_f32_16x16x32_bf16 v[124:127], v[172:175], v[232:235], v[124:127]
    ds_read_b64_tr_b16 v[156:157], v17 offset:49152
    ds_read_b64_tr_b16 v[158:159], v17 offset:50176
    v_mfma_f32_16x16x32_bf16 v[128:131], v[176:179], v[232:235], v[128:131]
    ds_read_b64_tr_b16 v[160:161], v18 offset:49152
    ds_read_b64_tr_b16 v[162:163], v18 offset:50176
    v_mfma_f32_16x16x32_bf16 v[132:135], v[180:183], v[232:235], v[132:135]
    ds_read_b64_tr_b16 v[164:165], v19 offset:49152
    ds_read_b64_tr_b16 v[166:167], v19 offset:50176
    v_mfma_f32_16x16x32_bf16 v[136:139], v[168:171], v[236:239], v[136:139]
    buffer_load_dwordx4 v[224:227], v20, s[56:59], s91 offen offset:3072 sc1
    buffer_load_dwordx4 v[228:231], v21, s[56:59], s91 offen offset:3072 sc1
    v_mfma_f32_16x16x32_bf16 v[140:143], v[172:175], v[236:239], v[140:143]
    v_mfma_f32_16x16x32_bf16 v[144:147], v[176:179], v[236:239], v[144:147]
    v_mfma_f32_16x16x32_bf16 v[148:151], v[180:183], v[236:239], v[148:151]
    s_waitcnt vmcnt(8) lgkmcnt(8)
    v_mfma_f32_16x16x32_bf16 v[120:123], v[184:187], v[240:243], v[120:123]
    ds_read_b64_tr_b16 v[168:169], v16 offset:53248
    ds_read_b64_tr_b16 v[170:171], v16 offset:54272
    v_mfma_f32_16x16x32_bf16 v[124:127], v[188:191], v[240:243], v[124:127]
    ds_read_b64_tr_b16 v[172:173], v17 offset:53248
    ds_read_b64_tr_b16 v[174:175], v17 offset:54272
    v_mfma_f32_16x16x32_bf16 v[128:131], v[192:195], v[240:243], v[128:131]
    ds_read_b64_tr_b16 v[176:177], v18 offset:53248
    ds_read_b64_tr_b16 v[178:179], v18 offset:54272
    v_mfma_f32_16x16x32_bf16 v[132:135], v[196:199], v[240:243], v[132:135]
    ds_read_b64_tr_b16 v[180:181], v19 offset:53248
    ds_read_b64_tr_b16 v[182:183], v19 offset:54272
    v_mfma_f32_16x16x32_bf16 v[136:139], v[184:187], v[244:247], v[136:139]
    v_mfma_f32_16x16x32_bf16 v[140:143], v[188:191], v[244:247], v[140:143]
    v_mfma_f32_16x16x32_bf16 v[144:147], v[192:195], v[244:247], v[144:147]
    v_mfma_f32_16x16x32_bf16 v[148:151], v[196:199], v[244:247], v[148:151]
    s_waitcnt vmcnt(6) lgkmcnt(8)
    v_mfma_f32_16x16x32_bf16 v[120:123], v[152:155], v[200:203], v[120:123]
    ds_read_b64_tr_b16 v[184:185], v16 offset:57344
    ds_read_b64_tr_b16 v[186:187], v16 offset:58368
    v_mfma_f32_16x16x32_bf16 v[124:127], v[156:159], v[200:203], v[124:127]
    ds_read_b64_tr_b16 v[188:189], v17 offset:57344
    ds_read_b64_tr_b16 v[190:191], v17 offset:58368
    v_mfma_f32_16x16x32_bf16 v[128:131], v[160:163], v[200:203], v[128:131]
    ds_read_b64_tr_b16 v[192:193], v18 offset:57344
    ds_read_b64_tr_b16 v[194:195], v18 offset:58368
    v_mfma_f32_16x16x32_bf16 v[132:135], v[164:167], v[200:203], v[132:135]
    ds_read_b64_tr_b16 v[196:197], v19 offset:57344
    ds_read_b64_tr_b16 v[198:199], v19 offset:58368
    v_mfma_f32_16x16x32_bf16 v[136:139], v[152:155], v[204:207], v[136:139]
    v_mfma_f32_16x16x32_bf16 v[140:143], v[156:159], v[204:207], v[140:143]
    v_mfma_f32_16x16x32_bf16 v[144:147], v[160:163], v[204:207], v[144:147]
    v_mfma_f32_16x16x32_bf16 v[148:151], v[164:167], v[204:207], v[148:151]
    s_waitcnt vmcnt(4) lgkmcnt(8)
    v_mfma_f32_16x16x32_bf16 v[120:123], v[168:171], v[208:211], v[120:123]
    ds_read_b64_tr_b16 v[152:153], v16 offset:61440
    ds_read_b64_tr_b16 v[154:155], v16 offset:62464
    v_mfma_f32_16x16x32_bf16 v[124:127], v[172:175], v[208:211], v[124:127]
    ds_read_b64_tr_b16 v[156:157], v17 offset:61440
    ds_read_b64_tr_b16 v[158:159], v17 offset:62464
    v_mfma_f32_16x16x32_bf16 v[128:131], v[176:179], v[208:211], v[128:131]
    ds_read_b64_tr_b16 v[160:161], v18 offset:61440
    ds_read_b64_tr_b16 v[162:163], v18 offset:62464
    v_mfma_f32_16x16x32_bf16 v[132:135], v[180:183], v[208:211], v[132:135]
    ds_read_b64_tr_b16 v[164:165], v19 offset:61440
    ds_read_b64_tr_b16 v[166:167], v19 offset:62464
    v_mfma_f32_16x16x32_bf16 v[136:139], v[168:171], v[212:215], v[136:139]
    v_mfma_f32_16x16x32_bf16 v[140:143], v[172:175], v[212:215], v[140:143]
    v_mfma_f32_16x16x32_bf16 v[144:147], v[176:179], v[212:215], v[144:147]
    v_mfma_f32_16x16x32_bf16 v[148:151], v[180:183], v[212:215], v[148:151]
    s_waitcnt vmcnt(2) lgkmcnt(8)
    v_mfma_f32_16x16x32_bf16 v[120:123], v[184:187], v[216:219], v[120:123]
    v_mfma_f32_16x16x32_bf16 v[124:127], v[188:191], v[216:219], v[124:127]
    v_mfma_f32_16x16x32_bf16 v[128:131], v[192:195], v[216:219], v[128:131]
    v_mfma_f32_16x16x32_bf16 v[132:135], v[196:199], v[216:219], v[132:135]
    v_mfma_f32_16x16x32_bf16 v[136:139], v[184:187], v[220:223], v[136:139]
    v_mfma_f32_16x16x32_bf16 v[140:143], v[188:191], v[220:223], v[140:143]
    v_mfma_f32_16x16x32_bf16 v[144:147], v[192:195], v[220:223], v[144:147]
    v_mfma_f32_16x16x32_bf16 v[148:151], v[196:199], v[220:223], v[148:151]
    s_waitcnt vmcnt(0) lgkmcnt(0)
    v_mfma_f32_16x16x32_bf16 v[120:123], v[152:155], v[224:227], v[120:123]
    v_mfma_f32_16x16x32_bf16 v[124:127], v[156:159], v[224:227], v[124:127]
    v_mfma_f32_16x16x32_bf16 v[128:131], v[160:163], v[224:227], v[128:131]
    v_mfma_f32_16x16x32_bf16 v[132:135], v[164:167], v[224:227], v[132:135]
    v_mfma_f32_16x16x32_bf16 v[136:139], v[152:155], v[228:231], v[136:139]
    v_mfma_f32_16x16x32_bf16 v[140:143], v[156:159], v[228:231], v[140:143]
    v_mfma_f32_16x16x32_bf16 v[144:147], v[160:163], v[228:231], v[144:147]
    v_mfma_f32_16x16x32_bf16 v[148:151], v[164:167], v[228:231], v[148:151]
    s_cmp_eq_u32 s84, 0
    s_cbranch_scc0 Lr_50
    s_nop 2
    ds_write_b128 v24, v[136:139] offset:0
    ds_write_b128 v24, v[140:143] offset:1024
    ds_write_b128 v24, v[144:147] offset:2048
    ds_write_b128 v24, v[148:151] offset:3072
    s_branch Lr_51
Lr_50:
    ds_write_b128 v24, v[120:123] offset:0
    ds_write_b128 v24, v[124:127] offset:1024
    ds_write_b128 v24, v[128:131] offset:2048
    ds_write_b128 v24, v[132:135] offset:3072
    v_mov_b32 v120, v136
    v_mov_b32 v121, v137
    v_mov_b32 v122, v138
    v_mov_b32 v123, v139
    v_mov_b32 v124, v140
    v_mov_b32 v125, v141
    v_mov_b32 v126, v142
    v_mov_b32 v127, v143
    v_mov_b32 v128, v144
    v_mov_b32 v129, v145
    v_mov_b32 v130, v146
    v_mov_b32 v131, v147
    v_mov_b32 v132, v148
    v_mov_b32 v133, v149
    v_mov_b32 v134, v150
    v_mov_b32 v135, v151
Lr_51:
    s_waitcnt lgkmcnt(0)
    s_barrier
    ds_read_b128 v[152:155], v25 offset:0
    ds_read_b128 v[156:159], v25 offset:1024
    ds_read_b128 v[160:163], v25 offset:2048
    ds_read_b128 v[164:167], v25 offset:3072
    s_waitcnt lgkmcnt(2)
    v_add_f32 v120, v120, v152
    v_add_f32 v121, v121, v153
    v_add_f32 v122, v122, v154
    v_add_f32 v123, v123, v155
    v_add_f32 v124, v124, v156
    v_add_f32 v125, v125, v157
    v_add_f32 v126, v126, v158
    v_add_f32 v127, v127, v159
    v_cvt_pk_bf16_f32 v168, v120, v121
    v_cvt_pk_bf16_f32 v169, v122, v123
    v_cvt_pk_bf16_f32 v170, v124, v125
    v_cvt_pk_bf16_f32 v171, v126, v127
    s_waitcnt lgkmcnt(0)
    v_add_f32 v128, v128, v160
    v_add_f32 v129, v129, v161
    v_add_f32 v130, v130, v162
    v_add_f32 v131, v131, v163
    v_add_f32 v132, v132, v164
    v_add_f32 v133, v133, v165
    v_add_f32 v134, v134, v166
    v_add_f32 v135, v135, v167
    v_cvt_pk_bf16_f32 v172, v128, v129
    v_cvt_pk_bf16_f32 v173, v130, v131
    v_cvt_pk_bf16_f32 v174, v132, v133
    v_cvt_pk_bf16_f32 v175, v134, v135
    v_permlane16_swap_b32 v168, v170
    v_permlane16_swap_b32 v169, v171
    ds_write_b128 v26, v[168:171]
    v_permlane16_swap_b32 v172, v174
    v_permlane16_swap_b32 v173, v175
    ds_write_b128 v27, v[172:175]
    ds_read_b128 v[152:155], v25 offset:0
    ds_read_b128 v[156:159], v25 offset:1024
    s_barrier
    s_waitcnt lgkmcnt(1)
    buffer_store_dwordx4 v[152:155], v28, s[52:55], s72 offen sc1
    s_waitcnt lgkmcnt(0)
    buffer_store_dwordx4 v[156:159], v28, s[52:55], s73 offen sc1
    s_barrier
    s_branch L_fin
L_lo2:
    s_add_u32 s92, s87, s85
    s_lshl_b32 s92, s92, 5
    s_add_u32 s92, s92, s86
    s_lshl_b32 s92, s92, 7
    s_add_u32 s92, s92, 0x1020000
    s_setprio 2
    s_waitcnt vmcnt(0)
    buffer_load_dword v253, v252, s[56:59], 0 offen sc1
    v_lshl_add_u32 v250, v0, 2, s92
    v_mov_b32 v251, s89
    s_mov_b32 exec_hi, 0
    buffer_store_dword v251, v250, s[56:59], 0 offen sc1
    s_mov_b32 exec_hi, -1
    s_waitcnt vmcnt(1)
    v_cmp_ne_u32 vcc, s89, v253
    s_nop 1
    s_cbranch_vccz Lv_53
    s_mov_b32 s96, 0
Lp_54:
    buffer_load_dword v253, v252, s[56:59], 0 offen sc1
Lpe_56:
    s_add_u32 s96, s96, 1
    s_waitcnt vmcnt(0)
    v_cmp_ne_u32 vcc, s89, v253
    s_cmp_ge_u32 s96, 32768
    s_cbranch_scc1 Lpd_55
    s_cbranch_vccz Lpd_55
    s_sleep 20
    s_branch Lp_54
Lpd_55:
Lv_53:
    s_add_u32 s90, s66, 0
    buffer_load_dwordx4 v[120:123], v212, s[56:59], s90 offen offset:0 sc1
    buffer_load_dwordx4 v[124:127], v212, s[56:59], s90 offen offset:2048 sc1
    s_add_u32 s90, s66, 4096
    buffer_load_dwordx4 v[128:131], v213, s[56:59], s90 offen offset:0 sc1
    buffer_load_dwordx4 v[132:135], v213, s[56:59], s90 offen offset:2048 sc1
    s_add_u32 s90, s66, 8192
    buffer_load_dwordx4 v[136:139], v214, s[56:59], s90 offen offset:0 sc1
    buffer_load_dwordx4 v[140:143], v214, s[56:59], s90 offen offset:2048 sc1
    s_add_u32 s90, s66, 12288
    buffer_load_dwordx4 v[144:147], v215, s[56:59], s90 offen offset:0 sc1
    buffer_load_dwordx4 v[148:151], v215, s[56:59], s90 offen offset:2048 sc1
    s_setprio 0
    ds_read_b128 v[56:59], v208 offset:4096
    ds_read_b128 v[60:63], v208 offset:6144
    ds_read_b128 v[64:67], v208 offset:4352
    ds_read_b128 v[68:71], v208 offset:6400
    ds_read_b128 v[24:27], v208 offset:0
    ds_read_b128 v[40:43], v209 offset:0
    ds_read_b128 v[28:31], v208 offset:2048
    ds_read_b128 v[44:47], v209 offset:2048
    ds_read_b128 v[32:35], v208 offset:256
    ds_read_b128 v[48:51], v209 offset:1024
    ds_read_b128 v[36:39], v208 offset:2304
    ds_read_b128 v[52:55], v209 offset:3072
    v_mov_b32 v72, v200
    v_mov_b32 v73, v201
    v_mov_b32 v74, v202
    v_mov_b32 v75, v203
    v_mov_b32 v76, v204
    v_mov_b32 v77, v205
    v_mov_b32 v78, v206
    v_mov_b32 v79, v207
    v_xor_b32 v2, 0, v211
    v_xor_b32 v3, 32, v211
    v_xor_b32 v4, 64, v211
    v_xor_b32 v5, 96, v211
    v_xor_b32 v6, 128, v211
    v_xor_b32 v7, 160, v211
    v_xor_b32 v8, 192, v211
    v_xor_b32 v9, 224, v211
    v_xor_b32 v10, 0, v210
    v_xor_b32 v11, 32, v210
    v_xor_b32 v12, 64, v210
    v_xor_b32 v13, 96, v210
    s_waitcnt lgkmcnt(0)
    s_barrier
    s_waitcnt vmcnt(7)
    ds_write_b128 v216, v[120:123] offset:0
    s_waitcnt vmcnt(6)
    ds_write_b128 v216, v[124:127] offset:4096
    s_waitcnt vmcnt(5)
    ds_write_b128 v216, v[128:131] offset:1024
    s_waitcnt vmcnt(4)
    ds_write_b128 v216, v[132:135] offset:5120
    s_waitcnt vmcnt(3)
    ds_write_b128 v216, v[136:139] offset:2048
    s_waitcnt vmcnt(2)
    ds_write_b128 v216, v[140:143] offset:6144
    s_waitcnt vmcnt(1)
    ds_write_b128 v216, v[144:147] offset:3072
    s_waitcnt vmcnt(0)
    ds_write_b128 v216, v[148:151] offset:7168
    v_lshlrev_b32 v88, 16, v56
    v_and_b32 v89, 0xffff0000, v56
    v_lshlrev_b32 v90, 16, v57
    v_and_b32 v91, 0xffff0000, v57
    v_lshlrev_b32 v92, 16, v58
    v_and_b32 v93, 0xffff0000, v58
    v_lshlrev_b32 v94, 16, v59
    v_and_b32 v95, 0xffff0000, v59
    v_lshlrev_b32 v96, 16, v60
    v_and_b32 v97, 0xffff0000, v60
    v_lshlrev_b32 v98, 16, v61
    v_and_b32 v99, 0xffff0000, v61
    v_lshlrev_b32 v100, 16, v62
    v_and_b32 v101, 0xffff0000, v62
    v_lshlrev_b32 v102, 16, v63
    v_and_b32 v103, 0xffff0000, v63
    v_lshlrev_b32 v104, 16, v64
    v_and_b32 v105, 0xffff0000, v64
    v_lshlrev_b32 v106, 16, v65
    v_and_b32 v107, 0xffff0000, v65
    v_lshlrev_b32 v108, 16, v66
    v_and_b32 v109, 0xffff0000, v66
    v_lshlrev_b32 v110, 16, v67
    v_and_b32 v111, 0xffff0000, v67
    v_lshlrev_b32 v112, 16, v68
    v_and_b32 v113, 0xffff0000, v68
    v_lshlrev_b32 v114, 16, v69
    v_and_b32 v115, 0xffff0000, v69
    v_lshlrev_b32 v116, 16, v70
    v_and_b32 v117, 0xffff0000, v70
    v_lshlrev_b32 v118, 16, v71
    v_and_b32 v119, 0xffff0000, v71
    v_xor_b32 v80, 0x80008000, v28
    v_xor_b32 v81, 0x80008000, v29
    v_xor_b32 v82, 0x80008000, v30
    v_xor_b32 v83, 0x80008000, v31
    v_xor_b32 v84, 0x80008000, v36
    v_xor_b32 v85, 0x80008000, v37
    v_xor_b32 v86, 0x80008000, v38
    v_xor_b32 v87, 0x80008000, v39
    s_waitcnt lgkmcnt(0)
    s_barrier
L_b2row:
    ds_read_b64_tr_b16 v[120:121], v2 offset:0
    ds_read_b64_tr_b16 v[122:123], v2 offset:16384
    ds_read_b64_tr_b16 v[124:125], v2 offset:4096
    ds_read_b64_tr_b16 v[126:127], v2 offset:20480
    ds_read_b64_tr_b16 v[128:129], v3 offset:0
    ds_read_b64_tr_b16 v[130:131], v3 offset:16384
    ds_read_b64_tr_b16 v[132:133], v3 offset:4096
    ds_read_b64_tr_b16 v[134:135], v3 offset:20480
    ds_read_b64_tr_b16 v[136:137], v4 offset:0
    ds_read_b64_tr_b16 v[138:139], v4 offset:16384
    ds_read_b64_tr_b16 v[140:141], v4 offset:4096
    ds_read_b64_tr_b16 v[142:143], v4 offset:20480
    ds_read_b64_tr_b16 v[144:145], v5 offset:0
    ds_read_b64_tr_b16 v[146:147], v5 offset:16384
    ds_read_b64_tr_b16 v[148:149], v5 offset:4096
    ds_read_b64_tr_b16 v[150:151], v5 offset:20480
    s_waitcnt lgkmcnt(8)
    v_mfma_f32_16x16x32_bf16 v[184:187], v[72:75], v[120:123], 0
    ds_read_b64_tr_b16 v[152:153], v6 offset:0
    ds_read_b64_tr_b16 v[154:155], v6 offset:16384
    ds_read_b64_tr_b16 v[156:157], v6 offset:4096
    v_mfma_f32_16x16x32_bf16 v[188:191], v[72:75], v[128:131], 0
    ds_read_b64_tr_b16 v[158:159], v6 offset:20480
    ds_read_b64_tr_b16 v[160:161], v7 offset:0
    ds_read_b64_tr_b16 v[162:163], v7 offset:16384
    v_mfma_f32_16x16x32_bf16 v[184:187], v[76:79], v[124:127], v[184:187]
    ds_read_b64_tr_b16 v[164:165], v7 offset:4096
    ds_read_b64_tr_b16 v[166:167], v7 offset:20480
    v_mfma_f32_16x16x32_bf16 v[188:191], v[76:79], v[132:135], v[188:191]
    s_waitcnt lgkmcnt(8)
    v_mfma_f32_16x16x32_bf16 v[192:195], v[72:75], v[136:139], 0
    ds_read_b64_tr_b16 v[168:169], v8 offset:0
    ds_read_b64_tr_b16 v[170:171], v8 offset:16384
    ds_read_b64_tr_b16 v[172:173], v8 offset:4096
    v_mfma_f32_16x16x32_bf16 v[196:199], v[72:75], v[144:147], 0
    ds_read_b64_tr_b16 v[174:175], v8 offset:20480
    ds_read_b64_tr_b16 v[176:177], v9 offset:0
    ds_read_b64_tr_b16 v[178:179], v9 offset:16384
    v_mfma_f32_16x16x32_bf16 v[192:195], v[76:79], v[140:143], v[192:195]
    ds_read_b64_tr_b16 v[180:181], v9 offset:4096
    ds_read_b64_tr_b16 v[182:183], v9 offset:20480
    v_mfma_f32_16x16x32_bf16 v[196:199], v[76:79], v[148:151], v[196:199]
    s_waitcnt lgkmcnt(8)
    v_mfma_f32_16x16x32_bf16 v[200:203], v[72:75], v[152:155], 0
    ds_read_b64_tr_b16 v[120:121], v2 offset:256
    ds_read_b64_tr_b16 v[122:123], v2 offset:16640
    ds_read_b64_tr_b16 v[124:125], v2 offset:4352
    v_mfma_f32_16x16x32_bf16 v[204:207], v[72:75], v[160:163], 0
    ds_read_b64_tr_b16 v[126:127], v2 offset:20736
    ds_read_b64_tr_b16 v[128:129], v3 offset:256
    ds_read_b64_tr_b16 v[130:131], v3 offset:16640
    v_mfma_f32_16x16x32_bf16 v[200:203], v[76:79], v[156:159], v[200:203]
    ds_read_b64_tr_b16 v[132:133], v3 offset:4352
    ds_read_b64_tr_b16 v[134:135], v3 offset:20736
    v_mfma_f32_16x16x32_bf16 v[204:207], v[76:79], v[164:167], v[204:207]
    s_waitcnt lgkmcnt(8)
    v_mfma_f32_16x16x32_bf16 v[208:211], v[72:75], v[168:171], 0
    ds_read_b64_tr_b16 v[136:137], v4 offset:256
    ds_read_b64_tr_b16 v[138:139], v4 offset:16640
    ds_read_b64_tr_b16 v[140:141], v4 offset:4352
    v_mfma_f32_16x16x32_bf16 v[212:215], v[72:75], v[176:179], 0
    ds_read_b64_tr_b16 v[142:143], v4 offset:20736
    ds_read_b64_tr_b16 v[144:145], v5 offset:256
    ds_read_b64_tr_b16 v[146:147], v5 offset:16640
    v_mfma_f32_16x16x32_bf16 v[208:211], v[76:79], v[172:175], v[208:211]
    ds_read_b64_tr_b16 v[148:149], v5 offset:4352
    ds_read_b64_tr_b16 v[150:151], v5 offset:20736
    v_cvt_pk_bf16_f32 v56, v184, v192
    v_mfma_f32_16x16x32_bf16 v[212:215], v[76:79], v[180:183], v[212:215]
    v_cvt_pk_bf16_f32 v64, v188, v196
    v_cvt_pk_bf16_f32 v60, v185, v193
    v_cvt_pk_bf16_f32 v68, v189, v197
    s_waitcnt lgkmcnt(8)
    v_mfma_f32_16x16x32_bf16 v[216:219], v[72:75], v[120:123], 0
    ds_read_b64_tr_b16 v[152:153], v6 offset:256
    ds_read_b64_tr_b16 v[154:155], v6 offset:16640
    ds_read_b64_tr_b16 v[156:157], v6 offset:4352
    v_mfma_f32_16x16x32_bf16 v[220:223], v[72:75], v[128:131], 0
    ds_read_b64_tr_b16 v[158:159], v6 offset:20736
    ds_read_b64_tr_b16 v[160:161], v7 offset:256
    ds_read_b64_tr_b16 v[162:163], v7 offset:16640
    v_mfma_f32_16x16x32_bf16 v[216:219], v[76:79], v[124:127], v[216:219]
    ds_read_b64_tr_b16 v[164:165], v7 offset:4352
    ds_read_b64_tr_b16 v[166:167], v7 offset:20736
    v_mfma_f32_16x16x32_bf16 v[220:223], v[76:79], v[132:135], v[220:223]
    s_waitcnt lgkmcnt(8)
    v_mfma_f32_16x16x32_bf16 v[224:227], v[72:75], v[136:139], 0
    ds_read_b64_tr_b16 v[168:169], v8 offset:256
    ds_read_b64_tr_b16 v[170:171], v8 offset:16640
    ds_read_b64_tr_b16 v[172:173], v8 offset:4352
    v_mfma_f32_16x16x32_bf16 v[228:231], v[72:75], v[144:147], 0
    ds_read_b64_tr_b16 v[174:175], v8 offset:20736
    ds_read_b64_tr_b16 v[176:177], v9 offset:256
    ds_read_b64_tr_b16 v[178:179], v9 offset:16640
    v_mfma_f32_16x16x32_bf16 v[224:227], v[76:79], v[140:143], v[224:227]
    ds_read_b64_tr_b16 v[180:181], v9 offset:4352
    ds_read_b64_tr_b16 v[182:183], v9 offset:20736
    v_cvt_pk_bf16_f32 v57, v200, v208
    v_mfma_f32_16x16x32_bf16 v[228:231], v[76:79], v[148:151], v[228:231]
    v_cvt_pk_bf16_f32 v65, v204, v212
    v_cvt_pk_bf16_f32 v61, v201, v209
    v_cvt_pk_bf16_f32 v69, v205, v213
    s_waitcnt lgkmcnt(8)
    v_mfma_f32_16x16x32_bf16 v[232:235], v[72:75], v[152:155], 0
    v_mfma_f32_16x16x32_bf16 v[236:239], v[72:75], v[160:163], 0
    v_mfma_f32_16x16x32_bf16 v[232:235], v[76:79], v[156:159], v[232:235]
    v_mfma_f32_16x16x32_bf16 v[236:239], v[76:79], v[164:167], v[236:239]
    s_waitcnt lgkmcnt(0)
    v_mfma_f32_16x16x32_bf16 v[240:243], v[72:75], v[168:171], 0
    v_cvt_pk_bf16_f32 v58, v216, v224
    v_cvt_pk_bf16_f32 v66, v220, v228
    v_cvt_pk_bf16_f32 v62, v217, v225
    v_mfma_f32_16x16x32_bf16 v[244:247], v[72:75], v[176:179], 0
    v_cvt_pk_bf16_f32 v70, v221, v229
    v_mfma_f32_16x16x32_bf16 v[240:243], v[76:79], v[172:175], v[240:243]
    v_mfma_f32_16x16x32_bf16 v[244:247], v[76:79], v[180:183], v[244:247]
    v_and_b32 v10, 15, v0
    v_lshrrev_b32 v11, 4, v0
    v_lshl_add_u32 v12, v10, 2, v11
    v_add_u32 v12, 1, v12
    v_and_b32 v10, 3, v12
    v_and_b32 v12, 60, v12
    v_lshl_add_u32 v12, v10, 6, v12
    v_cvt_pk_bf16_f32 v59, v232, v240
    v_cvt_pk_bf16_f32 v67, v236, v244
    v_cvt_pk_bf16_f32 v63, v233, v241
    v_cvt_pk_bf16_f32 v71, v237, v245
    v_mfma_f32_16x16x32_bf16 v[120:123], v[56:59], v[24:27], 0
    v_mfma_f32_16x16x32_bf16 v[124:127], v[64:67], v[24:27], 0
    v_mfma_f32_16x16x32_bf16 v[128:131], v[56:59], v[28:31], 0
    v_mfma_f32_16x16x32_bf16 v[132:135], v[64:67], v[28:31], 0
    v_mfma_f32_16x16x32_bf16 v[120:123], v[60:63], v[80:83], v[120:123]
    v_mfma_f32_16x16x32_bf16 v[124:127], v[68:71], v[80:83], v[124:127]
    v_mfma_f32_16x16x32_bf16 v[128:131], v[60:63], v[24:27], v[128:131]
    v_mfma_f32_16x16x32_bf16 v[132:135], v[68:71], v[24:27], v[132:135]
    v_mfma_f32_16x16x32_bf16 v[136:139], v[56:59], v[32:35], 0
    v_mfma_f32_16x16x32_bf16 v[140:143], v[64:67], v[32:35], 0
    v_mfma_f32_16x16x32_bf16 v[144:147], v[56:59], v[36:39], 0
    v_mfma_f32_16x16x32_bf16 v[148:151], v[64:67], v[36:39], 0
    v_mfma_f32_16x16x32_bf16 v[136:139], v[60:63], v[84:87], v[136:139]
    v_mfma_f32_16x16x32_bf16 v[140:143], v[68:71], v[84:87], v[140:143]
    v_mfma_f32_16x16x32_bf16 v[144:147], v[60:63], v[32:35], v[144:147]
    v_mfma_f32_16x16x32_bf16 v[148:151], v[68:71], v[32:35], v[148:151]
    v_mul_f32 v184, v120, v88
    v_mul_f32 v192, v120, v96
    v_fma_f32 v184, -v128, v96, v184
    v_fma_f32 v192, -v128, v88, -v192
    v_mul_f32 v185, v121, v89
    v_mul_f32 v193, v121, v97
    v_fma_f32 v185, -v129, v97, v185
    v_fma_f32 v193, -v129, v89, -v193
    v_mul_f32 v186, v122, v90
    v_mul_f32 v194, v122, v98
    v_fma_f32 v186, -v130, v98, v186
    v_fma_f32 v194, -v130, v90, -v194
    v_mul_f32 v187, v123, v91
    v_mul_f32 v195, v123, v99
    v_fma_f32 v187, -v131, v99, v187
    v_fma_f32 v195, -v131, v91, -v195
    v_mul_f32 v188, v124, v92
    v_mul_f32 v196, v124, v100
    v_fma_f32 v188, -v132, v100, v188
    v_fma_f32 v196, -v132, v92, -v196
    v_mul_f32 v189, v125, v93
    v_mul_f32 v197, v125, v101
    v_fma_f32 v189, -v133, v101, v189
    v_fma_f32 v197, -v133, v93, -v197
    v_mul_f32 v190, v126, v94
    v_mul_f32 v198, v126, v102
    v_fma_f32 v190, -v134, v102, v190
    v_fma_f32 v198, -v134, v94, -v198
    v_mul_f32 v191, v127, v95
    v_mul_f32 v199, v127, v103
    v_fma_f32 v191, -v135, v103, v191
    v_fma_f32 v199, -v135, v95, -v199
    v_cvt_pk_bf16_f32 v216, v184, v185
    v_cvt_pk_bf16_f32 v217, v186, v187
    v_cvt_pk_bf16_f32 v218, v188, v189
    v_cvt_pk_bf16_f32 v219, v190, v191
    v_cvt_pk_bf16_f32 v220, v192, v193
    v_cvt_pk_bf16_f32 v221, v194, v195
    v_cvt_pk_bf16_f32 v222, v196, v197
    v_cvt_pk_bf16_f32 v223, v198, v199
    v_mfma_f32_16x16x32_bf16 v[232:235], v[216:219], v[40:43], 0
    v_mfma_f32_16x16x32_bf16 v[240:243], v[216:219], v[48:51], 0
    v_mfma_f32_16x16x32_bf16 v[232:235], v[220:223], v[44:47], v[232:235]
    v_mfma_f32_16x16x32_bf16 v[240:243], v[220:223], v[52:55], v[240:243]
    v_mul_f32 v200, v136, v104
    v_mul_f32 v208, v136, v112
    v_fma_f32 v200, -v144, v112, v200
    v_fma_f32 v208, -v144, v104, -v208
    v_mul_f32 v201, v137, v105
    v_mul_f32 v209, v137, v113
    v_fma_f32 v201, -v145, v113, v201
    v_fma_f32 v209, -v145, v105, -v209
    v_mul_f32 v202, v138, v106
    v_mul_f32 v210, v138, v114
    v_fma_f32 v202, -v146, v114, v202
    v_fma_f32 v210, -v146, v106, -v210
    v_mul_f32 v203, v139, v107
    v_mul_f32 v211, v139, v115
    v_fma_f32 v203, -v147, v115, v203
    v_fma_f32 v211, -v147, v107, -v211
    v_mul_f32 v204, v140, v108
    v_mul_f32 v212, v140, v116
    v_fma_f32 v204, -v148, v116, v204
    v_fma_f32 v212, -v148, v108, -v212
    v_mul_f32 v205, v141, v109
    v_mul_f32 v213, v141, v117
    v_fma_f32 v205, -v149, v117, v205
    v_fma_f32 v213, -v149, v109, -v213
    v_mul_f32 v206, v142, v110
    v_mul_f32 v214, v142, v118
    v_fma_f32 v206, -v150, v118, v206
    v_fma_f32 v214, -v150, v110, -v214
    v_mul_f32 v207, v143, v111
    v_mul_f32 v215, v143, v119
    v_fma_f32 v207, -v151, v119, v207
    v_fma_f32 v215, -v151, v111, -v215
    v_cvt_pk_bf16_f32 v224, v200, v201
    v_cvt_pk_bf16_f32 v225, v202, v203
    v_cvt_pk_bf16_f32 v226, v204, v205
    v_cvt_pk_bf16_f32 v227, v206, v207
    v_cvt_pk_bf16_f32 v228, v208, v209
    v_cvt_pk_bf16_f32 v229, v210, v211
    v_cvt_pk_bf16_f32 v230, v212, v213
    v_cvt_pk_bf16_f32 v231, v214, v215
    v_mfma_f32_16x16x32_bf16 v[236:239], v[224:227], v[40:43], 0
    v_mfma_f32_16x16x32_bf16 v[244:247], v[224:227], v[48:51], 0
    v_mfma_f32_16x16x32_bf16 v[236:239], v[228:231], v[44:47], v[236:239]
    v_mfma_f32_16x16x32_bf16 v[244:247], v[228:231], v[52:55], v[244:247]
    v_and_b32 v10, 3, v0
    v_and_b32 v13, 60, v0
    v_lshl_add_u32 v13, v10, 6, v13
    s_lshl_b32 s90, s74, 12
    s_add_u32 s91, s90, 2048
    s_sub_u32 s92, 0x800bf0, s90
    v_add_u32 v14, s91, v1
    v_sub_u32 v15, s92, v1
    ds_bpermute_b32 v10, v12, v232
    ds_bpermute_b32 v11, v12, v240
    v_cvt_pk_bf16_f32 v56, v232, v233
    v_cvt_pk_bf16_f32 v57, v234, v235
    ds_bpermute_b32 v56, v13, v56
    v_cvt_pk_bf16_f32 v58, v236, v237
    ds_bpermute_b32 v57, v13, v57
    v_cvt_pk_bf16_f32 v59, v238, v239
    ds_bpermute_b32 v58, v13, v58
    v_cvt_pk_bf16_f32 v60, v240, v241
    ds_bpermute_b32 v59, v13, v59
    v_cvt_pk_bf16_f32 v61, v242, v243
    ds_bpermute_b32 v60, v13, v60
    v_cvt_pk_bf16_f32 v62, v244, v245
    ds_bpermute_b32 v61, v13, v61
    v_cvt_pk_bf16_f32 v63, v246, v247
    ds_bpermute_b32 v62, v13, v62
    s_mov_b32 vcc_lo, 0
    s_mov_b32 vcc_hi, 0x80000000
    ds_bpermute_b32 v63, v13, v63
    s_waitcnt lgkmcnt(8)
    v_cndmask_b32 v248, v10, v11, vcc
    v_cndmask_b32 v249, v11, v10, vcc
    v_cvt_pk_bf16_f32 v64, v248, v239
    v_cvt_pk_bf16_f32 v65, v238, v237
    v_cvt_pk_bf16_f32 v66, v236, v235
    v_cvt_pk_bf16_f32 v67, v234, v233
    v_cvt_pk_bf16_f32 v68, v249, v247
    v_cvt_pk_bf16_f32 v69, v246, v245
    v_cvt_pk_bf16_f32 v70, v244, v243
    v_cvt_pk_bf16_f32 v71, v242, v241
    s_waitcnt lgkmcnt(0)
    ds_bpermute_b32 v64, v13, v64
    ds_bpermute_b32 v65, v13, v65
    ds_bpermute_b32 v66, v13, v66
    ds_bpermute_b32 v67, v13, v67
    ds_bpermute_b32 v68, v13, v68
    ds_bpermute_b32 v69, v13, v69
    ds_bpermute_b32 v70, v13, v70
    ds_bpermute_b32 v71, v13, v71
    s_cmp_eq_u32 s74, 0
    s_cbranch_scc0 Lb2e_57
    buffer_store_dwordx4 v[56:59], v14, s[52:55], 0 offen offset:0 sc1
    buffer_store_dwordx4 v[60:63], v14, s[52:55], 0 offen offset:1024 sc1
    s_waitcnt lgkmcnt(4)
    buffer_store_dwordx4 v[64:67], v15, s[52:55], 0 offen offset:1024 sc1
    s_waitcnt lgkmcnt(0)
    buffer_store_dwordx4 v[68:71], v15, s[52:55], 0 offen offset:0 sc1
    s_mov_b32 s74, 1024
    v_cvt_f32_u32 v184, s74
    v_mul_f32 v184, 0x3a000000, v184
    v_and_b32 v185, 1, v0
    v_cvt_f32_u32 v185, v185
    v_mul_f32 v185, 0x3e800000, v185
    v_cos_f32 v186, v185
    v_sin_f32 v194, v185
    v_add_f32 v185, v185, v184
    v_cos_f32 v187, v185
    v_sin_f32 v195, v185
    v_add_f32 v185, v185, v184
    v_cos_f32 v188, v185
    v_sin_f32 v196, v185
    v_add_f32 v185, v185, v184
    v_cos_f32 v189, v185
    v_sin_f32 v197, v185
    v_add_f32 v185, v185, v184
    v_cos_f32 v190, v185
    v_sin_f32 v198, v185
    v_add_f32 v185, v185, v184
    v_cos_f32 v191, v185
    v_sin_f32 v199, v185
    v_add_f32 v185, v185, v184
    v_cos_f32 v192, v185
    v_sin_f32 v200, v185
    v_add_f32 v185, v185, v184
    v_cos_f32 v193, v185
    v_sin_f32 v201, v185
    s_mov_b32 s90, 0x300003
    s_mov_b32 s91, 0x30000300
    s_cmp_eq_u32 s76, 2
    s_cselect_b64 vcc, -1, 0
    v_cvt_pk_bf16_f32 v186, v186, v187
    v_cvt_pk_bf16_f32 v194, v194, v195
    v_cndmask_b32 v194, v194, v186, vcc
    v_cvt_pk_bf16_f32 v187, v188, v189
    v_cvt_pk_bf16_f32 v195, v196, v197
    v_cndmask_b32 v195, v195, v187, vcc
    v_cvt_pk_bf16_f32 v188, v190, v191
    v_cvt_pk_bf16_f32 v196, v198, v199
    v_cndmask_b32 v196, v196, v188, vcc
    v_cvt_pk_bf16_f32 v189, v192, v193
    v_cvt_pk_bf16_f32 v197, v200, v201
    v_cndmask_b32 v197, v197, v189, vcc
    s_cselect_b64 vcc, 0, s[90:91]
    v_cndmask_b32 v72, 0, v186, vcc
    v_cndmask_b32 v73, 0, v187, vcc
    v_cndmask_b32 v74, 0, v188, vcc
    v_cndmask_b32 v75, 0, v189, vcc
    s_cmp_eq_u32 s76, 1
    s_cselect_b64 vcc, 0, s[90:91]
    v_cndmask_b32 v76, 0, v194, vcc
    v_cndmask_b32 v77, 0, v195, vcc
    v_cndmask_b32 v78, 0, v196, vcc
    v_cndmask_b32 v79, 0, v197, vcc
    s_branch L_b2row
Lb2e_57:
    s_lshl_b32 s93, s79, 2
    s_and_b32 s90, s3, 1
    s_add_u32 s93, s93, s90
    s_lshl_b32 s90, s93, 1
    s_add_u32 s90, s90, s84
    s_lshl_b32 s90, s90, 11
    s_add_u32 s90, s90, 0x1020000
    v_lshl_add_u32 v22, v0, 7, s90
    v_lshrrev_b32 v17, 2, v0
    v_and_b32 v17, 7, v17
    v_lshrrev_b32 v18, 1, v17
    v_lshlrev_b32 v18, 5, v18
    v_lshl_add_u32 v16, v17, 7, v18
    v_and_b32 v17, 32, v0
    v_lshl_add_u32 v16, v17, 6, v16
    v_and_b32 v17, 3, v0
    v_lshl_add_u32 v16, v17, 3, v16
    s_lshl_b32 s90, s84, 16
    s_add_u32 s90, s90, 32768
    v_add_u32 v16, s90, v16
    v_xor_b32 v17, 32, v16
    v_xor_b32 v18, 64, v16
    v_xor_b32 v19, 96, v16
    s_lshl_b32 s90, s93, 16
    s_lshl_b32 s91, s84, 14
    s_add_u32 s90, s90, s91
    s_add_u32 s90, s90, 0x800000
    v_add_u32 v20, s90, v1
    v_add_u32 v21, 0x8000, v20
    s_mov_b64 exec, 0xffff
    buffer_load_dword v253, v22, s[56:59], 0 offen sc1
    s_mov_b64 exec, -1
    s_lshl_b32 s90, s3, 12
    v_add_u32 v24, s90, v1
    v_xor_b32 v25, 0x2000, v24
    v_and_b32 v26, 15, v0
    v_lshrrev_b32 v27, 3, v0
    v_and_b32 v27, 2, v27
    v_lshrrev_b32 v28, 5, v0
    v_or_b32 v27, v27, v28
    v_and_b32 v28, 7, v0
    v_xor_b32 v27, v27, v28
    v_lshlrev_b32 v27, 4, v27
    v_lshl_add_u32 v26, v26, 7, v27
    s_xor_b32 s90, s90, 0x2000
    v_add_u32 v26, s90, v26
    v_xor_b32 v27, 64, v26
    v_lshrrev_b32 v29, 3, v0
    v_xor_b32 v28, v28, v29
    v_lshlrev_b32 v28, 4, v28
    v_lshl_add_u32 v28, v29, 12, v28
    s_lshl_b32 s72, s93, 17
    s_lshl_b32 s91, s84, 16
    s_add_u32 s72, s72, s91
    s_lshl_b32 s91, s78, 7
    s_add_u32 s72, s72, s91
    s_add_u32 s73, s72, 32768
    s_waitcnt lgkmcnt(0)
    ds_read_b64_tr_b16 v[152:153], v16 offset:0
    ds_read_b64_tr_b16 v[154:155], v16 offset:1024
    ds_read_b64_tr_b16 v[156:157], v17 offset:0
    ds_read_b64_tr_b16 v[158:159], v17 offset:1024
    ds_read_b64_tr_b16 v[160:161], v18 offset:0
    ds_read_b64_tr_b16 v[162:163], v18 offset:1024
    ds_read_b64_tr_b16 v[164:165], v19 offset:0
    ds_read_b64_tr_b16 v[166:167], v19 offset:1024
    ds_read_b64_tr_b16 v[168:169], v16 offset:4096
    ds_read_b64_tr_b16 v[170:171], v16 offset:5120
    ds_read_b64_tr_b16 v[172:173], v17 offset:4096
    ds_read_b64_tr_b16 v[174:175], v17 offset:5120
    ds_read_b64_tr_b16 v[176:177], v18 offset:4096
    ds_read_b64_tr_b16 v[178:179], v18 offset:5120
    ds_read_b64_tr_b16 v[180:181], v19 offset:4096
    ds_read_b64_tr_b16 v[182:183], v19 offset:5120
    s_mov_b32 s96, 0
    s_mov_b64 exec, 0xffff
    s_branch Lpe_60
Lp_58:
    buffer_load_dword v253, v22, s[56:59], 0 offen sc1
Lpe_60:
    s_add_u32 s96, s96, 1
    s_waitcnt vmcnt(0)
    v_cmp_ne_u32 vcc, s89, v253
    s_cmp_ge_u32 s96, 32768
    s_cbranch_scc1 Lpd_59
    s_cbranch_vccz Lpd_59
    s_sleep 2
    s_branch Lp_58
Lpd_59:
    s_mov_b64 exec, -1
    s_mov_b32 s91, 0
    buffer_load_dwordx4 v[200:203], v20, s[56:59], s91 offen offset:0 sc1
    buffer_load_dwordx4 v[204:207], v21, s[56:59], s91 offen offset:0 sc1
    buffer_load_dwordx4 v[208:211], v20, s[56:59], s91 offen offset:1024 sc1
    buffer_load_dwordx4 v[212:215], v21, s[56:59], s91 offen offset:1024 sc1
    buffer_load_dwordx4 v[216:219], v20, s[56:59], s91 offen offset:2048 sc1
    buffer_load_dwordx4 v[220:223], v21, s[56:59], s91 offen offset:2048 sc1
    buffer_load_dwordx4 v[224:227], v20, s[56:59], s91 offen offset:3072 sc1
    buffer_load_dwordx4 v[228:231], v21, s[56:59], s91 offen offset:3072 sc1
    s_mov_b32 s91, 4096
    buffer_load_dwordx4 v[232:235], v20, s[56:59], s91 offen offset:0 sc1
    buffer_load_dwordx4 v[236:239], v21, s[56:59], s91 offen offset:0 sc1
    s_barrier
    s_waitcnt vmcnt(8) lgkmcnt(8)
    v_mfma_f32_16x16x32_bf16 v[120:123], v[152:155], v[200:203], 0
    ds_read_b64_tr_b16 v[184:185], v16 offset:8192
    ds_read_b64_tr_b16 v[186:187], v16 offset:9216
    v_mfma_f32_16x16x32_bf16 v[124:127], v[156:159], v[200:203], 0
    ds_read_b64_tr_b16 v[188:189], v17 offset:8192
    ds_read_b64_tr_b16 v[190:191], v17 offset:9216
    v_mfma_f32_16x16x32_bf16 v[128:131], v[160:163], v[200:203], 0
    ds_read_b64_tr_b16 v[192:193], v18 offset:8192
    ds_read_b64_tr_b16 v[194:195], v18 offset:9216
    v_mfma_f32_16x16x32_bf16 v[132:135], v[164:167], v[200:203], 0
    ds_read_b64_tr_b16 v[196:197], v19 offset:8192
    ds_read_b64_tr_b16 v[198:199], v19 offset:9216
    v_mfma_f32_16x16x32_bf16 v[136:139], v[152:155], v[204:207], 0
    buffer_load_dwordx4 v[240:243], v20, s[56:59], s91 offen offset:1024 sc1
    buffer_load_dwordx4 v[244:247], v21, s[56:59], s91 offen offset:1024 sc1
    v_mfma_f32_16x16x32_bf16 v[140:143], v[156:159], v[204:207], 0
    v_mfma_f32_16x16x32_bf16 v[144:147], v[160:163], v[204:207], 0
    v_mfma_f32_16x16x32_bf16 v[148:151], v[164:167], v[204:207], 0
    s_waitcnt vmcnt(8) lgkmcnt(8)
    v_mfma_f32_16x16x32_bf16 v[120:123], v[168:171], v[208:211], v[120:123]
    ds_read_b64_tr_b16 v[152:153], v16 offset:12288
    ds_read_b64_tr_b16 v[154:155], v16 offset:13312
    v_mfma_f32_16x16x32_bf16 v[124:127], v[172:175], v[208:211], v[124:127]
    ds_read_b64_tr_b16 v[156:157], v17 offset:12288
    ds_read_b64_tr_b16 v[158:159], v17 offset:13312
    v_mfma_f32_16x16x32_bf16 v[128:131], v[176:179], v[208:211], v[128:131]
    ds_read_b64_tr_b16 v[160:161], v18 offset:12288
    ds_read_b64_tr_b16 v[162:163], v18 offset:13312
    v_mfma_f32_16x16x32_bf16 v[132:135], v[180:183], v[208:211], v[132:135]
    ds_read_b64_tr_b16 v[164:165], v19 offset:12288
    ds_read_b64_tr_b16 v[166:167], v19 offset:13312
    v_mfma_f32_16x16x32_bf16 v[136:139], v[168:171], v[212:215], v[136:139]
    buffer_load_dwordx4 v[200:203], v20, s[56:59], s91 offen offset:2048 sc1
    buffer_load_dwordx4 v[204:207], v21, s[56:59], s91 offen offset:2048 sc1
    v_mfma_f32_16x16x32_bf16 v[140:143], v[172:175], v[212:215], v[140:143]
    v_mfma_f32_16x16x32_bf16 v[144:147], v[176:179], v[212:215], v[144:147]
    v_mfma_f32_16x16x32_bf16 v[148:151], v[180:183], v[212:215], v[148:151]
    s_waitcnt vmcnt(8) lgkmcnt(8)
    v_mfma_f32_16x16x32_bf16 v[120:123], v[184:187], v[216:219], v[120:123]
    ds_read_b64_tr_b16 v[168:169], v16 offset:16384
    ds_read_b64_tr_b16 v[170:171], v16 offset:17408
    v_mfma_f32_16x16x32_bf16 v[124:127], v[188:191], v[216:219], v[124:127]
    ds_read_b64_tr_b16 v[172:173], v17 offset:16384
    ds_read_b64_tr_b16 v[174:175], v17 offset:17408
    v_mfma_f32_16x16x32_bf16 v[128:131], v[192:195], v[216:219], v[128:131]
    ds_read_b64_tr_b16 v[176:177], v18 offset:16384
    ds_read_b64_tr_b16 v[178:179], v18 offset:17408
    v_mfma_f32_16x16x32_bf16 v[132:135], v[196:199], v[216:219], v[132:135]
    ds_read_b64_tr_b16 v[180:181], v19 offset:16384
    ds_read_b64_tr_b16 v[182:183], v19 offset:17408
    v_mfma_f32_16x16x32_bf16 v[136:139], v[184:187], v[220:223], v[136:139]
    buffer_load_dwordx4 v[208:211], v20, s[56:59], s91 offen offset:3072 sc1
    buffer_load_dwordx4 v[212:215], v21, s[56:59], s91 offen offset:3072 sc1
    v_mfma_f32_16x16x32_bf16 v[140:143], v[188:191], v[220:223], v[140:143]
    v_mfma_f32_16x16x32_bf16 v[144:147], v[192:195], v[220:223], v[144:147]
    v_mfma_f32_16x16x32_bf16 v[148:151], v[196:199], v[220:223], v[148:151]
    s_waitcnt vmcnt(8) lgkmcnt(8)
    v_mfma_f32_16x16x32_bf16 v[120:123], v[152:155], v[224:227], v[120:123]
    ds_read_b64_tr_b16 v[184:185], v16 offset:20480
    ds_read_b64_tr_b16 v[186:187], v16 offset:21504
    v_mfma_f32_16x16x32_bf16 v[124:127], v[156:159], v[224:227], v[124:127]
    ds_read_b64_tr_b16 v[188:189], v17 offset:20480
    ds_read_b64_tr_b16 v[190:191], v17 offset:21504
    v_mfma_f32_16x16x32_bf16 v[128:131], v[160:163], v[224:227], v[128:131]
    ds_read_b64_tr_b16 v[192:193], v18 offset:20480
    ds_read_b64_tr_b16 v[194:195], v18 offset:21504
    v_mfma_f32_16x16x32_bf16 v[132:135], v[164:167], v[224:227], v[132:135]
    ds_read_b64_tr_b16 v[196:197], v19 offset:20480
    ds_read_b64_tr_b16 v[198:199], v19 offset:21504
    v_mfma_f32_16x16x32_bf16 v[136:139], v[152:155], v[228:231], v[136:139]
    s_mov_b32 s91, 8192
    buffer_load_dwordx4 v[216:219], v20, s[56:59], s91 offen offset:0 sc1
    v_mfma_f32_16x16x32_bf16 v[140:143], v[156:159], v[228:231], v[140:143]
    buffer_load_dwordx4 v[220:223], v21, s[56:59], s91 offen offset:0 sc1
    v_mfma_f32_16x16x32_bf16 v[144:147], v[160:163], v[228:231], v[144:147]
    v_mfma_f32_16x16x32_bf16 v[148:151], v[164:167], v[228:231], v[148:151]
    s_waitcnt vmcnt(8) lgkmcnt(8)
    v_mfma_f32_16x16x32_bf16 v[120:123], v[168:171], v[232:235], v[120:123]
    ds_read_b64_tr_b16 v[152:153], v16 offset:24576
    ds_read_b64_tr_b16 v[154:155], v16 offset:25600
    v_mfma_f32_16x16x32_bf16 v[124:127], v[172:175], v[232:235], v[124:127]
    ds_read_b64_tr_b16 v[156:157], v17 offset:24576
    ds_read_b64_tr_b16 v[158:159], v17 offset:25600
    v_mfma_f32_16x16x32_bf16 v[128:131], v[176:179], v[232:235], v[128:131]
    ds_read_b64_tr_b16 v[160:161], v18 offset:24576
    ds_read_b64_tr_b16 v[162:163], v18 offset:25600
    v_mfma_f32_16x16x32_bf16 v[132:135], v[180:183], v[232:235], v[132:135]
    ds_read_b64_tr_b16 v[164:165], v19 offset:24576
    ds_read_b64_tr_b16 v[166:167], v19 offset:25600
    v_mfma_f32_16x16x32_bf16 v[136:139], v[168:171], v[236:239], v[136:139]
    buffer_load_dwordx4 v[224:227], v20, s[56:59], s91 offen offset:1024 sc1
    buffer_load_dwordx4 v[228:231], v21, s[56:59], s91 offen offset:1024 sc1
    v_mfma_f32_16x16x32_bf16 v[140:143], v[172:175], v[236:239], v[140:143]
    v_mfma_f32_16x16x32_bf16 v[144:147], v[176:179], v[236:239], v[144:147]
    v_mfma_f32_16x16x32_bf16 v[148:151], v[180:183], v[236:239], v[148:151]
    s_barrier
    s_waitcnt vmcnt(8) lgkmcnt(8)
    v_mfma_f32_16x16x32_bf16 v[120:123], v[184:187], v[240:243], v[120:123]
    ds_read_b64_tr_b16 v[168:169], v16 offset:28672
    ds_read_b64_tr_b16 v[170:171], v16 offset:29696
    v_mfma_f32_16x16x32_bf16 v[124:127], v[188:191], v[240:243], v[124:127]
    ds_read_b64_tr_b16 v[172:173], v17 offset:28672
    ds_read_b64_tr_b16 v[174:175], v17 offset:29696
    v_mfma_f32_16x16x32_bf16 v[128:131], v[192:195], v[240:243], v[128:131]
    ds_read_b64_tr_b16 v[176:177], v18 offset:28672
    ds_read_b64_tr_b16 v[178:179], v18 offset:29696
    v_mfma_f32_16x16x32_bf16 v[132:135], v[196:199], v[240:243], v[132:135]
    ds_read_b64_tr_b16 v[180:181], v19 offset:28672
    ds_read_b64_tr_b16 v[182:183], v19 offset:29696
    v_mfma_f32_16x16x32_bf16 v[136:139], v[184:187], v[244:247], v[136:139]
    buffer_load_dwordx4 v[232:235], v20, s[56:59], s91 offen offset:2048 sc1
    buffer_load_dwordx4 v[236:239], v21, s[56:59], s91 offen offset:2048 sc1
    v_mfma_f32_16x16x32_bf16 v[140:143], v[188:191], v[244:247], v[140:143]
    v_mfma_f32_16x16x32_bf16 v[144:147], v[192:195], v[244:247], v[144:147]
    v_mfma_f32_16x16x32_bf16 v[148:151], v[196:199], v[244:247], v[148:151]
    s_waitcnt vmcnt(8) lgkmcnt(8)
    v_mfma_f32_16x16x32_bf16 v[120:123], v[152:155], v[200:203], v[120:123]
    ds_read_b64_tr_b16 v[184:185], v16 offset:32768
    ds_read_b64_tr_b16 v[186:187], v16 offset:33792
    v_mfma_f32_16x16x32_bf16 v[124:127], v[156:159], v[200:203], v[124:127]
    ds_read_b64_tr_b16 v[188:189], v17 offset:32768
    ds_read_b64_tr_b16 v[190:191], v17 offset:33792
    v_mfma_f32_16x16x32_bf16 v[128:131], v[160:163], v[200:203], v[128:131]
    ds_read_b64_tr_b16 v[192:193], v18 offset:32768
    ds_read_b64_tr_b16 v[194:195], v18 offset:33792
    v_mfma_f32_16x16x32_bf16 v[132:135], v[164:167], v[200:203], v[132:135]
    ds_read_b64_tr_b16 v[196:197], v19 offset:32768
    ds_read_b64_tr_b16 v[198:199], v19 offset:33792
    v_mfma_f32_16x16x32_bf16 v[136:139], v[152:155], v[204:207], v[136:139]
    buffer_load_dwordx4 v[240:243], v20, s[56:59], s91 offen offset:3072 sc1
    buffer_load_dwordx4 v[244:247], v21, s[56:59], s91 offen offset:3072 sc1
    v_mfma_f32_16x16x32_bf16 v[140:143], v[156:159], v[204:207], v[140:143]
    v_mfma_f32_16x16x32_bf16 v[144:147], v[160:163], v[204:207], v[144:147]
    v_mfma_f32_16x16x32_bf16 v[148:151], v[164:167], v[204:207], v[148:151]
    s_waitcnt vmcnt(8) lgkmcnt(8)
    v_mfma_f32_16x16x32_bf16 v[120:123], v[168:171], v[208:211], v[120:123]
    ds_read_b64_tr_b16 v[152:153], v16 offset:36864
    ds_read_b64_tr_b16 v[154:155], v16 offset:37888
    v_mfma_f32_16x16x32_bf16 v[124:127], v[172:175], v[208:211], v[124:127]
    ds_read_b64_tr_b16 v[156:157], v17 offset:36864
    ds_read_b64_tr_b16 v[158:159], v17 offset:37888
    v_mfma_f32_16x16x32_bf16 v[128:131], v[176:179], v[208:211], v[128:131]
    ds_read_b64_tr_b16 v[160:161], v18 offset:36864
    ds_read_b64_tr_b16 v[162:163], v18 offset:37888
    v_mfma_f32_16x16x32_bf16 v[132:135], v[180:183], v[208:211], v[132:135]
    ds_read_b64_tr_b16 v[164:165], v19 offset:36864
    ds_read_b64_tr_b16 v[166:167], v19 offset:37888
    v_mfma_f32_16x16x32_bf16 v[136:139], v[168:171], v[212:215], v[136:139]
    s_mov_b32 s91, 12288
    buffer_load_dwordx4 v[200:203], v20, s[56:59], s91 offen offset:0 sc1
    v_mfma_f32_16x16x32_bf16 v[140:143], v[172:175], v[212:215], v[140:143]
    buffer_load_dwordx4 v[204:207], v21, s[56:59], s91 offen offset:0 sc1
    v_mfma_f32_16x16x32_bf16 v[144:147], v[176:179], v[212:215], v[144:147]
    v_mfma_f32_16x16x32_bf16 v[148:151], v[180:183], v[212:215], v[148:151]
    s_waitcnt vmcnt(8) lgkmcnt(8)
    v_mfma_f32_16x16x32_bf16 v[120:123], v[184:187], v[216:219], v[120:123]
    ds_read_b64_tr_b16 v[168:169], v16 offset:40960
    ds_read_b64_tr_b16 v[170:171], v16 offset:41984
    v_mfma_f32_16x16x32_bf16 v[124:127], v[188:191], v[216:219], v[124:127]
    ds_read_b64_tr_b16 v[172:173], v17 offset:40960
    ds_read_b64_tr_b16 v[174:175], v17 offset:41984
    v_mfma_f32_16x16x32_bf16 v[128:131], v[192:195], v[216:219], v[128:131]
    ds_read_b64_tr_b16 v[176:177], v18 offset:40960
    ds_read_b64_tr_b16 v[178:179], v18 offset:41984
    v_mfma_f32_16x16x32_bf16 v[132:135], v[196:199], v[216:219], v[132:135]
    ds_read_b64_tr_b16 v[180:181], v19 offset:40960
    ds_read_b64_tr_b16 v[182:183], v19 offset:41984
    v_mfma_f32_16x16x32_bf16 v[136:139], v[184:187], v[220:223], v[136:139]
    buffer_load_dwordx4 v[208:211], v20, s[56:59], s91 offen offset:1024 sc1
    buffer_load_dwordx4 v[212:215], v21, s[56:59], s91 offen offset:1024 sc1
    v_mfma_f32_16x16x32_bf16 v[140:143], v[188:191], v[220:223], v[140:143]
    v_mfma_f32_16x16x32_bf16 v[144:147], v[192:195], v[220:223], v[144:147]
    v_mfma_f32_16x16x32_bf16 v[148:151], v[196:199], v[220:223], v[148:151]
    s_waitcnt vmcnt(8) lgkmcnt(8)
    v_mfma_f32_16x16x32_bf16 v[120:123], v[152:155], v[224:227], v[120:123]
    ds_read_b64_tr_b16 v[184:185], v16 offset:45056
    ds_read_b64_tr_b16 v[186:187], v16 offset:46080
    v_mfma_f32_16x16x32_bf16 v[124:127], v[156:159], v[224:227], v[124:127]
    ds_read_b64_tr_b16 v[188:189], v17 offset:45056
    ds_read_b64_tr_b16 v[190:191], v17 offset:46080
    v_mfma_f32_16x16x32_bf16 v[128:131], v[160:163], v[224:227], v[128:131]
    ds_read_b64_tr_b16 v[192:193], v18 offset:45056
    ds_read_b64_tr_b16 v[194:195], v18 offset:46080
    v_mfma_f32_16x16x32_bf16 v[132:135], v[164:167], v[224:227], v[132:135]
    ds_read_b64_tr_b16 v[196:197], v19 offset:45056
    ds_read_b64_tr_b16 v[198:199], v19 offset:46080
    v_mfma_f32_16x16x32_bf16 v[136:139], v[152:155], v[228:231], v[136:139]
    buffer_load_dwordx4 v[216:219], v20, s[56:59], s91 offen offset:2048 sc1
    buffer_load_dwordx4 v[220:223], v21, s[56:59], s91 offen offset:2048 sc1
    v_mfma_f32_16x16x32_bf16 v[140:143], v[156:159], v[228:231], v[140:143]
    v_mfma_f32_16x16x32_bf16 v[144:147], v[160:163], v[228:231], v[144:147]
    v_mfma_f32_16x16x32_bf16 v[148:151], v[164:167], v[228:231], v[148:151]
    s_waitcnt vmcnt(8) lgkmcnt(8)
    v_mfma_f32_16x16x32_bf16 v[120:123], v[168:171], v[232:235], v[120:123]
    ds_read_b64_tr_b16 v[152:153], v16 offset:49152
    ds_read_b64_tr_b16 v[154:155], v16 offset:50176
    v_mfma_f32_16x16x32_bf16 v[124:127], v[172:175], v[232:235], v[124:127]
    ds_read_b64_tr_b16 v[156:157], v17 offset:49152
    ds_read_b64_tr_b16 v[158:159], v17 offset:50176
    v_mfma_f32_16x16x32_bf16 v[128:131], v[176:179], v[232:235], v[128:131]
    ds_read_b64_tr_b16 v[160:161], v18 offset:49152
    ds_read_b64_tr_b16 v[162:163], v18 offset:50176
    v_mfma_f32_16x16x32_bf16 v[132:135], v[180:183], v[232:235], v[132:135]
    ds_read_b64_tr_b16 v[164:165], v19 offset:49152
    ds_read_b64_tr_b16 v[166:167], v19 offset:50176
    v_mfma_f32_16x16x32_bf16 v[136:139], v[168:171], v[236:239], v[136:139]
    buffer_load_dwordx4 v[224:227], v20, s[56:59], s91 offen offset:3072 sc1
    buffer_load_dwordx4 v[228:231], v21, s[56:59], s91 offen offset:3072 sc1
    v_mfma_f32_16x16x32_bf16 v[140:143], v[172:175], v[236:239], v[140:143]
    v_mfma_f32_16x16x32_bf16 v[144:147], v[176:179], v[236:239], v[144:147]
    v_mfma_f32_16x16x32_bf16 v[148:151], v[180:183], v[236:239], v[148:151]
    s_barrier
    s_waitcnt vmcnt(8) lgkmcnt(8)
    v_mfma_f32_16x16x32_bf16 v[120:123], v[184:187], v[240:243], v[120:123]
    ds_read_b64_tr_b16 v[168:169], v16 offset:53248
    ds_read_b64_tr_b16 v[170:171], v16 offset:54272
    v_mfma_f32_16x16x32_bf16 v[124:127], v[188:191], v[240:243], v[124:127]
    ds_read_b64_tr_b16 v[172:173], v17 offset:53248
    ds_read_b64_tr_b16 v[174:175], v17 offset:54272
    v_mfma_f32_16x16x32_bf16 v[128:131], v[192:195], v[240:243], v[128:131]
    ds_read_b64_tr_b16 v[176:177], v18 offset:53248
    ds_read_b64_tr_b16 v[178:179], v18 offset:54272
    v_mfma_f32_16x16x32_bf16 v[132:135], v[196:199], v[240:243], v[132:135]
    ds_read_b64_tr_b16 v[180:181], v19 offset:53248
    ds_read_b64_tr_b16 v[182:183], v19 offset:54272
    v_mfma_f32_16x16x32_bf16 v[136:139], v[184:187], v[244:247], v[136:139]
    buffer_store_dwordx4 v[56:59], v14, s[52:55], 0 offen offset:0 sc1
    v_mfma_f32_16x16x32_bf16 v[140:143], v[188:191], v[244:247], v[140:143]
    v_mfma_f32_16x16x32_bf16 v[144:147], v[192:195], v[244:247], v[144:147]
    v_mfma_f32_16x16x32_bf16 v[148:151], v[196:199], v[244:247], v[148:151]
    s_waitcnt vmcnt(7) lgkmcnt(8)
    v_mfma_f32_16x16x32_bf16 v[120:123], v[152:155], v[200:203], v[120:123]
    ds_read_b64_tr_b16 v[184:185], v16 offset:57344
    ds_read_b64_tr_b16 v[186:187], v16 offset:58368
    v_mfma_f32_16x16x32_bf16 v[124:127], v[156:159], v[200:203], v[124:127]
    ds_read_b64_tr_b16 v[188:189], v17 offset:57344
    ds_read_b64_tr_b16 v[190:191], v17 offset:58368
    v_mfma_f32_16x16x32_bf16 v[128:131], v[160:163], v[200:203], v[128:131]
    ds_read_b64_tr_b16 v[192:193], v18 offset:57344
    ds_read_b64_tr_b16 v[194:195], v18 offset:58368
    v_mfma_f32_16x16x32_bf16 v[132:135], v[164:167], v[200:203], v[132:135]
    ds_read_b64_tr_b16 v[196:197], v19 offset:57344
    ds_read_b64_tr_b16 v[198:199], v19 offset:58368
    v_mfma_f32_16x16x32_bf16 v[136:139], v[152:155], v[204:207], v[136:139]
    buffer_store_dwordx4 v[60:63], v14, s[52:55], 0 offen offset:1024 sc1
    v_mfma_f32_16x16x32_bf16 v[140:143], v[156:159], v[204:207], v[140:143]
    v_mfma_f32_16x16x32_bf16 v[144:147], v[160:163], v[204:207], v[144:147]
    v_mfma_f32_16x16x32_bf16 v[148:151], v[164:167], v[204:207], v[148:151]
    s_waitcnt vmcnt(6) lgkmcnt(8)
    v_mfma_f32_16x16x32_bf16 v[120:123], v[168:171], v[208:211], v[120:123]
    ds_read_b64_tr_b16 v[152:153], v16 offset:61440
    ds_read_b64_tr_b16 v[154:155], v16 offset:62464
    v_mfma_f32_16x16x32_bf16 v[124:127], v[172:175], v[208:211], v[124:127]
    ds_read_b64_tr_b16 v[156:157], v17 offset:61440
    ds_read_b64_tr_b16 v[158:159], v17 offset:62464
    v_mfma_f32_16x16x32_bf16 v[128:131], v[176:179], v[208:211], v[128:131]
    ds_read_b64_tr_b16 v[160:161], v18 offset:61440
    ds_read_b64_tr_b16 v[162:163], v18 offset:62464
    v_mfma_f32_16x16x32_bf16 v[132:135], v[180:183], v[208:211], v[132:135]
    ds_read_b64_tr_b16 v[164:165], v19 offset:61440
    ds_read_b64_tr_b16 v[166:167], v19 offset:62464
    v_mfma_f32_16x16x32_bf16 v[136:139], v[168:171], v[212:215], v[136:139]
    buffer_store_dwordx4 v[64:67], v15, s[52:55], 0 offen offset:1024 sc1
    v_mfma_f32_16x16x32_bf16 v[140:143], v[172:175], v[212:215], v[140:143]
    v_mfma_f32_16x16x32_bf16 v[144:147], v[176:179], v[212:215], v[144:147]
    v_mfma_f32_16x16x32_bf16 v[148:151], v[180:183], v[212:215], v[148:151]
    s_waitcnt vmcnt(5) lgkmcnt(8)
    v_mfma_f32_16x16x32_bf16 v[120:123], v[184:187], v[216:219], v[120:123]
    buffer_store_dwordx4 v[68:71], v15, s[52:55], 0 offen offset:0 sc1
    v_mfma_f32_16x16x32_bf16 v[124:127], v[188:191], v[216:219], v[124:127]
    v_mfma_f32_16x16x32_bf16 v[128:131], v[192:195], v[216:219], v[128:131]
    v_mfma_f32_16x16x32_bf16 v[132:135], v[196:199], v[216:219], v[132:135]
    v_mfma_f32_16x16x32_bf16 v[136:139], v[184:187], v[220:223], v[136:139]
    v_mfma_f32_16x16x32_bf16 v[140:143], v[188:191], v[220:223], v[140:143]
    v_mfma_f32_16x16x32_bf16 v[144:147], v[192:195], v[220:223], v[144:147]
    v_mfma_f32_16x16x32_bf16 v[148:151], v[196:199], v[220:223], v[148:151]
    s_waitcnt vmcnt(4) lgkmcnt(0)
    v_mfma_f32_16x16x32_bf16 v[120:123], v[152:155], v[224:227], v[120:123]
    v_mfma_f32_16x16x32_bf16 v[124:127], v[156:159], v[224:227], v[124:127]
    v_mfma_f32_16x16x32_bf16 v[128:131], v[160:163], v[224:227], v[128:131]
    v_mfma_f32_16x16x32_bf16 v[132:135], v[164:167], v[224:227], v[132:135]
    v_mfma_f32_16x16x32_bf16 v[136:139], v[152:155], v[228:231], v[136:139]
    v_mfma_f32_16x16x32_bf16 v[140:143], v[156:159], v[228:231], v[140:143]
    v_mfma_f32_16x16x32_bf16 v[144:147], v[160:163], v[228:231], v[144:147]
    v_mfma_f32_16x16x32_bf16 v[148:151], v[164:167], v[228:231], v[148:151]
    s_cmp_eq_u32 s84, 0
    s_cbranch_scc0 Lr_61
    s_nop 2
    ds_write_b128 v24, v[136:139] offset:0
    ds_write_b128 v24, v[140:143] offset:1024
    ds_write_b128 v24, v[144:147] offset:2048
    ds_write_b128 v24, v[148:151] offset:3072
    s_branch Lr_62
Lr_61:
    ds_write_b128 v24, v[120:123] offset:0
    ds_write_b128 v24, v[124:127] offset:1024
    ds_write_b128 v24, v[128:131] offset:2048
    ds_write_b128 v24, v[132:135] offset:3072
    v_mov_b32 v120, v136
    v_mov_b32 v121, v137
    v_mov_b32 v122, v138
    v_mov_b32 v123, v139
    v_mov_b32 v124, v140
    v_mov_b32 v125, v141
    v_mov_b32 v126, v142
    v_mov_b32 v127, v143
    v_mov_b32 v128, v144
    v_mov_b32 v129, v145
    v_mov_b32 v130, v146
    v_mov_b32 v131, v147
    v_mov_b32 v132, v148
    v_mov_b32 v133, v149
    v_mov_b32 v134, v150
    v_mov_b32 v135, v151
Lr_62:
    s_waitcnt lgkmcnt(0)
    s_barrier
    ds_read_b128 v[152:155], v25 offset:0
    ds_read_b128 v[156:159], v25 offset:1024
    ds_read_b128 v[160:163], v25 offset:2048
    ds_read_b128 v[164:167], v25 offset:3072
    s_waitcnt lgkmcnt(2)
    v_add_f32 v120, v120, v152
    v_add_f32 v121, v121, v153
    v_add_f32 v122, v122, v154
    v_add_f32 v123, v123, v155
    v_add_f32 v124, v124, v156
    v_add_f32 v125, v125, v157
    v_add_f32 v126, v126, v158
    v_add_f32 v127, v127, v159
    v_cvt_pk_bf16_f32 v168, v120, v121
    v_cvt_pk_bf16_f32 v169, v122, v123
    v_cvt_pk_bf16_f32 v170, v124, v125
    v_cvt_pk_bf16_f32 v171, v126, v127
    s_waitcnt lgkmcnt(0)
    v_add_f32 v128, v128, v160
    v_add_f32 v129, v129, v161
    v_add_f32 v130, v130, v162
    v_add_f32 v131, v131, v163
    v_add_f32 v132, v132, v164
    v_add_f32 v133, v133, v165
    v_add_f32 v134, v134, v166
    v_add_f32 v135, v135, v167
    v_cvt_pk_bf16_f32 v172, v128, v129
    v_cvt_pk_bf16_f32 v173, v130, v131
    v_cvt_pk_bf16_f32 v174, v132, v133
    v_cvt_pk_bf16_f32 v175, v134, v135
    v_permlane16_swap_b32 v168, v170
    v_permlane16_swap_b32 v169, v171
    ds_write_b128 v26, v[168:171]
    v_permlane16_swap_b32 v172, v174
    v_permlane16_swap_b32 v173, v175
    ds_write_b128 v27, v[172:175]
    ds_read_b128 v[152:155], v25 offset:0
    ds_read_b128 v[156:159], v25 offset:1024
    s_waitcnt lgkmcnt(1)
    buffer_store_dwordx4 v[152:155], v28, s[52:55], s72 offen sc1
    s_waitcnt lgkmcnt(0)
    buffer_store_dwordx4 v[156:159], v28, s[52:55], s73 offen sc1
    s_or_b32 s90, s2, s3
    s_cbranch_scc1 Lep_63
    s_mov_b32 s90, 0x10a0000
    v_lshl_add_u32 v250, v0, 2, s90
    v_mov_b32 v251, s89
    s_mov_b32 exec_hi, 0
    buffer_store_dword v251, v250, s[56:59], 0 offen sc1
    s_mov_b32 exec_hi, -1
Lep_63:
L_fin:
L_end:
    s_endpgm
.section .rodata,"a"
.p2align 6
.amdhsa_kernel concat_heads__sliding_block__spectral_fnet__prompt_kernel
  .amdhsa_next_free_vgpr 256
  .amdhsa_next_free_sgpr 102
  .amdhsa_accum_offset 256
  .amdhsa_group_segment_fixed_size 0
  .amdhsa_kernarg_size 88
  .amdhsa_user_sgpr_count 2
  .amdhsa_user_sgpr_kernarg_segment_ptr 1
  .amdhsa_system_sgpr_workgroup_id_x 1
  .amdhsa_float_denorm_mode_32 3
  .amdhsa_float_denorm_mode_16_64 3
.end_amdhsa_kernel
```
